```python
import torch

def _softmax(x, axis=-1):
    return torch.softmax(x, dim=axis)
def _gelu(x):
    return torch.nn.functional.gelu(x, approximate="tanh")
def _silu(x):
    return torch.nn.functional.silu(x)
def _sigmoid(x):
    return torch.sigmoid(x)
def _layernorm(x, axis=-1, eps=1e-5):
    m = x.mean(dim=axis, keepdim=True)
    v = x.var(dim=axis, keepdim=True, unbiased=False)
    return (x - m) / torch.sqrt(v + eps)
def _scatter_add(tgt, idx, src, axis=0):
    return tgt.clone().index_add_(axis, idx, src)
def _segment_sum(src, seg, n):
    out = torch.zeros((n,) + src.shape[1:], dtype=src.dtype)
    return out.index_add_(0, seg, src)
def _pad(x, pw):
    flat = tuple(v for pair in reversed(pw) for v in pair)
    return torch.nn.functional.pad(x, flat)

kernel_name = 'concat_heads__ssm_conv_h3__ssm_conv_h3__prompt'

def setup_inputs():

    _w = (lambda a: (lambda t: t.to(torch.bfloat16) if t.is_floating_point() else t)(torch.as_tensor(a)))
    def _A_setup():
        B, S, D = 1, 2048, 576
        ks = 4
        return {
            "q": _w((lambda *s: torch.randn(*s, dtype=torch.bfloat16) * 0.05)(B, S, D)),
            "k": _w((lambda *s: torch.randn(*s, dtype=torch.bfloat16) * 0.05)(B, S, D)),
            "v": _w((lambda *s: torch.randn(*s, dtype=torch.bfloat16) * 0.05)(B, S, D)),
            "shift_k": _w((lambda *s: torch.randn(*s, dtype=torch.bfloat16) * 0.05)(D, ks) * 0.5),
            "ssm_k": _w((lambda *s: torch.randn(*s, dtype=torch.bfloat16) * 0.05)(D, S) * (1.0 / S ** 0.5)),
            "ssm_D": _w((lambda *s: torch.randn(*s, dtype=torch.bfloat16) * 0.05)(D)),
        }
    _A_in = _A_setup()

    def _B_setup():
        B, S, D = 1, 2048, 576
        ks = 4
        return {
            "q": _w((lambda *s: torch.randn(*s, dtype=torch.bfloat16) * 0.05)(B, S, D)),
            "k": _w((lambda *s: torch.randn(*s, dtype=torch.bfloat16) * 0.05)(B, S, D)),
            "v": _w((lambda *s: torch.randn(*s, dtype=torch.bfloat16) * 0.05)(B, S, D)),
            "shift_k": _w((lambda *s: torch.randn(*s, dtype=torch.bfloat16) * 0.05)(D, ks) * 0.5),
            "ssm_k": _w((lambda *s: torch.randn(*s, dtype=torch.bfloat16) * 0.05)(D, S) * (1.0 / S ** 0.5)),
            "ssm_D": _w((lambda *s: torch.randn(*s, dtype=torch.bfloat16) * 0.05)(D)),
        }
    _B_in = _B_setup()

    return {
        "A_q": _A_in["q"],
        "A_k": _A_in["k"],
        "A_v": _A_in["v"],
        "A_shift_k": _A_in["shift_k"],
        "A_ssm_k": _A_in["ssm_k"],
        "A_ssm_D": _A_in["ssm_D"],
        "B_q": _B_in["q"],
        "B_k": _B_in["k"],
        "B_v": _B_in["v"],
        "B_shift_k": _B_in["shift_k"],
        "B_ssm_k": _B_in["ssm_k"],
        "B_ssm_D": _B_in["ssm_D"],
    }

def reference(A_q, A_k, A_v, A_shift_k, A_ssm_k, A_ssm_D, B_q, B_k, B_v, B_shift_k, B_ssm_k, B_ssm_D):
    def _A_ref(q, k, v, shift_k, ssm_k, ssm_D):
        B, S, D = q.shape
        ks = shift_k.shape[-1]
        k_pad = _pad(k, ((0, 0), (ks - 1, 0), (0, 0)))
        k_shift = torch.zeros_like(k)
        for t in range(ks):
            k_shift = k_shift + k_pad[:, t:t + S, :] * shift_k[:, ks - 1 - t][None, None, :]
        kv = k_shift * v
        L = 2 * S
        kv_pad = _pad(kv, ((0, 0), (0, S), (0, 0)))
        kf_pad = _pad(ssm_k, ((0, 0), (0, S)))
        kv_f = (lambda x, axes=(-2,-1): torch.fft.rfft2(x.float(), dim=axes))(kv_pad[:, None, :, :], axes=(1, 2))
        kf_f = (lambda x, axes=(-2,-1): torch.fft.rfft2(x.float(), dim=axes))(kf_pad[:, None, :], axes=(1, 2))
        kf_f = (lambda x, *d: x.permute(*d))(kf_f, 1, 2, 0)
        y_f = kv_f * kf_f[None, :, :, :]
        y = (lambda x, s, axes=(-2,-1): torch.fft.irfft2(x, s=s, dim=axes).to(torch.bfloat16))(y_f, (1, L), axes=(1, 2))[:, 0, :S, :]
        y = y + kv * ssm_D[None, None, :]
        return q * y

    def _B_ref(q, k, v, shift_k, ssm_k, ssm_D):
        B, S, D = q.shape
        ks = shift_k.shape[-1]
        k_pad = _pad(k, ((0, 0), (ks - 1, 0), (0, 0)))
        k_shift = torch.zeros_like(k)
        for t in range(ks):
            k_shift = k_shift + k_pad[:, t:t + S, :] * shift_k[:, ks - 1 - t][None, None, :]
        kv = k_shift * v
        L = 2 * S
        kv_pad = _pad(kv, ((0, 0), (0, S), (0, 0)))
        kf_pad = _pad(ssm_k, ((0, 0), (0, S)))
        kv_f = (lambda x, axes=(-2,-1): torch.fft.rfft2(x.float(), dim=axes))(kv_pad[:, None, :, :], axes=(1, 2))
        kf_f = (lambda x, axes=(-2,-1): torch.fft.rfft2(x.float(), dim=axes))(kf_pad[:, None, :], axes=(1, 2))
        kf_f = (lambda x, *d: x.permute(*d))(kf_f, 1, 2, 0)
        y_f = kv_f * kf_f[None, :, :, :]
        y = (lambda x, s, axes=(-2,-1): torch.fft.irfft2(x, s=s, dim=axes).to(torch.bfloat16))(y_f, (1, L), axes=(1, 2))[:, 0, :S, :]
        y = y + kv * ssm_D[None, None, :]
        return q * y

    a = _A_ref(A_q, A_k, A_v, A_shift_k, A_ssm_k, A_ssm_D)
    b = _B_ref(B_q, B_k, B_v, B_shift_k, B_ssm_k, B_ssm_D)
    return torch.concatenate([a, b], axis=-1)
```

```asm
; @launch grid=(256,1,1) block=(512,1,1) lds=141440
.amdgcn_target "amdgcn-amd-amdhsa--gfx950"
.text
.p2align 12
.globl concat_heads__ssm_conv_h3__ssm_conv_h3__prompt_kernel
.p2align 8
.type concat_heads__ssm_conv_h3__ssm_conv_h3__prompt_kernel,@function
concat_heads__ssm_conv_h3__ssm_conv_h3__prompt_kernel:
    s_cmp_ge_u32 s2, 256
    s_cbranch_scc1 L_end
    s_getpc_b64 s[92:93]
L_pc:
    s_mov_b32 s94, L_codeend-L_pc
    s_mov_b32 s95, 0x00020000
    v_lshlrev_b32 v10, 7, v0
    buffer_load_dword v200, v10, s[92:95], 0 offen
    s_and_b32 s4, s2, 7
    s_lshr_b32 s6, s4, 2
    s_mul_i32 s26, s6, 48
    s_add_u32 s26, s0, s26
    s_addc_u32 s27, s1, 0
    s_load_dwordx8 s[8:15], s[26:27], 0
    s_load_dwordx4 s[16:19], s[26:27], 32
    s_load_dwordx4 s[20:23], s[0:1], 96
    s_load_dwordx2 s[24:25], s[0:1], 112
    v_lshrrev_b32 v1, 6, v0
    s_lshr_b32 s5, s2, 3
    v_readfirstlane_b32 s3, v1
    v_and_b32 v0, 63, v0
    s_and_b32 s56, s4, 3
    s_lshl_b32 s101, s56, 5
    s_add_u32 s101, s101, 1024
    s_lshl_b32 s56, s56, 8
    s_mul_i32 s57, s5, 32*1152
    s_add_u32 s57, s57, s56
    s_and_b32 s7, s3, 3
    s_cmp_lt_u32 s3, 4
    s_cbranch_scc1 L_H
    s_barrier
    s_branch L_M
L_clr:
    s_lshl_b32 s40, s4, 11
    s_add_u32 s40, s40, 16777216
    s_add_u32 s40, s24, s40
    s_addc_u32 s41, s25, 0
    s_mov_b32 s42, 67584
    s_mov_b32 s43, 0x00020000
    v_mov_b32 v12, 0
    v_mov_b32 v13, 0
    v_mov_b32 v14, 0
    v_mov_b32 v15, 0
    v_lshlrev_b32 v10, 4, v0
    s_mov_b32 s60, 65536
    buffer_store_dwordx4 v[12:15], v10, s[40:43], s60 offen offset:0 sc1
    buffer_store_dwordx4 v[12:15], v10, s[40:43], s60 offen offset:1024 sc1
    buffer_store_dwordx4 v[12:15], v10, s[40:43], 0 offen offset:0
    buffer_store_dwordx4 v[12:15], v10, s[40:43], 0 offen offset:1024
    s_branch L_noclr
L_H:
    v_and_b32 v8, 15, v0
    v_lshrrev_b32 v9, 4, v0
    s_and_b32 s60, s7, 1
    s_lshl_b32 s60, s60, 3
    v_lshl_add_u32 v10, v9, 1, s60
    v_xor_b32 v10, v10, v8
    v_mul_u32_u24 v2, 1152, v9
    v_lshl_add_u32 v2, v10, 4, v2
    s_mul_i32 s58, s7, 4608
    s_add_u32 s58, s58, s57
    s_add_u32 s59, s58, 18432
    s_lshl_b32 s62, s7, 10
    s_cmp_eq_u32 s5, 0
    s_cselect_b32 s60, 0x80000000, 0
    s_cselect_b32 s86, 0, 4608
    v_or_b32 v3, s60, v2
    s_sub_u32 s86, s57, s86
    v_mov_b32 v10, 141312
    v_lshl_add_u32 v10, v8, 3, v10
    v_mov_b32 v66, 0
    v_mov_b32 v67, 0
    ds_write_b64 v10, v[66:67]
    s_mov_b32 s30, 2359296
    s_mov_b32 s31, 0x00020000
    s_or_b32 s60, s5, s7
    s_cmp_lg_u32 s60, 0
    s_waitcnt lgkmcnt(0)
    s_mov_b32 s28, s10
    s_mov_b32 s29, s11
    s_cbranch_scc0 L_clr
L_noclr:
    s_add_u32 m0, s62, 1024
    s_nop 0
    buffer_load_dwordx4 v2, s[28:31], s58 offen  lds
    s_add_u32 m0, s62, 5120
    s_nop 0
    buffer_load_dwordx4 v2, s[28:31], s59 offen  lds
    s_cmp_lg_u32 s7, 3
    s_cbranch_scc1 L_nh92
    s_mov_b32 m0, 0
    s_nop 0
    buffer_load_dwordx4 v3, s[28:31], s86 offen  lds
L_nh92:
    s_mov_b32 s32, s14
    s_mov_b32 s33, s15
    s_movk_i32 s34, 4608
    s_mov_b32 s35, 0x00020000
    s_mov_b32 s14, 2359296
    s_mov_b32 s15, 0x00020000
    s_lshl_b32 s88, s56, 2
    s_lshl_b32 s89, s7, 8
    s_add_u32 s89, s89, s88
    s_lshl_b32 s88, s101, 2
    v_lshlrev_b32 v18, 3, v8
    buffer_load_dwordx2 v[12:13], v18, s[32:35], s89 offen
    buffer_load_dwordx2 v[14:15], v18, s[32:35], s89 offen offset:128
    buffer_load_dwordx2 v[16:17], v18, s[32:35], s88 offen
    s_add_u32 m0, s62, 12288
    s_nop 0
    buffer_load_dwordx4 v2, s[12:15], s58 offen  lds
    s_add_u32 m0, s62, 16384
    s_nop 0
    buffer_load_dwordx4 v2, s[12:15], s59 offen  lds
    s_cmp_ge_u32 s7, 2
    s_cbranch_scc1 L_noex
    s_mul_i32 s60, s5, 32*1152
    s_mul_i32 s85, s7, 1179648
    s_add_u32 s60, s60, s85
    s_add_u32 s60, s60, s101
    v_lshrrev_b32 v10, 1, v0
    v_mul_u32_u24 v10, 1152, v10
    v_and_b32 v11, 1, v0
    v_lshl_add_u32 v10, v11, 4, v10
    v_add_u32 v22, s60, v10
    v_subrev_u32 v20, 3456, v22
    v_add_u32 v21, 36864, v20
    v_cmp_gt_u32 vcc, 6, v0
    v_bfrev_b32 v11, 1
    s_mul_i32 s85, s7, 3072
    s_add_u32 m0, s85, 135168
    v_cndmask_b32 v21, v11, v21, vcc
    buffer_load_dwordx4 v20, s[28:31], 0 offen  lds
    s_add_u32 m0, s85, 136192
    s_nop 0
    buffer_load_dwordx4 v21, s[28:31], 0 offen  lds
    s_add_u32 m0, s85, 137216
    s_nop 0
    buffer_load_dwordx4 v22, s[12:15], 0 offen  lds
L_noex:
    s_barrier
    s_setprio 1
    s_mov_b32 s44, s22
    s_mov_b32 s45, s23
    s_mov_b32 s46, 256
    s_mov_b32 s47, 0x00020000
    s_mov_b32 s52, s20
    s_mov_b32 s53, s21
    s_mov_b32 s54, 4718592
    s_mov_b32 s55, 0x00020000
    s_mov_b32 s48, s8
    s_mov_b32 s49, s9
    s_mov_b32 s50, 2359296
    s_mov_b32 s51, 0x00020000
    s_getreg_b32 s63, hwreg(HW_REG_XCC_ID, 0, 4)
    s_add_u32 s63, s63, 1
    s_lshl_b32 s90, s4, 2
    v_and_b32 v10, 1, v0
    v_lshlrev_b32 v10, 4, v10
    v_mov_b32 v11, 0xffff
    v_lshlrev_b32 v10, v10, v11
    v_lshrrev_b32 v11, 1, v8
    v_and_b32 v18, 1, v9
    v_lshlrev_b32 v18, 2, v18
    v_sub_u32 v11, v11, v18
    v_cmp_eq_u32 vcc, 0, v11
    s_nop 1
    v_cndmask_b32 v20, 0, v10, vcc
    v_cmp_eq_u32 vcc, 1, v11
    s_nop 1
    v_cndmask_b32 v21, 0, v10, vcc
    v_cmp_eq_u32 vcc, 2, v11
    s_nop 1
    v_cndmask_b32 v22, 0, v10, vcc
    v_cmp_eq_u32 vcc, 3, v11
    s_nop 1
    v_cndmask_b32 v23, 0, v10, vcc
    v_cmp_gt_u32 vcc, 2, v9
    v_mov_b32 v10, 0x3f803f80
    s_nop 0
    v_cndmask_b32 v11, 0, v10, vcc
    v_and_b32 v24, v20, v11
    v_and_b32 v25, v21, v11
    v_and_b32 v26, v22, v11
    v_and_b32 v27, v23, v11
    v_bfe_u32 v10, v0, 2, 1
    v_bfe_u32 v11, v0, 3, 1
    v_lshl_add_u32 v10, v11, 4, v10
    v_and_b32 v11, 3, v0
    v_lshlrev_b32 v11, 1, v11
    v_sub_u32 v10, v10, v11
    v_add_u32 v10, 6, v10
    v_and_b32 v11, 1, v9
    s_lshl_b32 s60, s7, 2
    v_add_u32 v11, s60, v11
    v_and_b32 v18, 7, v10
    v_lshlrev_b32 v18, 1, v18
    v_xor_b32 v18, v18, v11
    v_lshl_add_u32 v18, v10, 4, v18
    v_lshlrev_b32 v238, 4, v18
    v_xor_b32 v239, 32, v238
    v_lshrrev_b32 v19, 1, v9
    v_sub_u32 v19, v10, v19
    v_and_b32 v18, 7, v19
    v_lshlrev_b32 v18, 1, v18
    v_xor_b32 v18, v18, v11
    v_lshl_add_u32 v18, v19, 4, v18
    v_add_u32 v18, 64, v18
    v_lshlrev_b32 v234, 4, v18
    v_xor_b32 v235, 32, v234
    v_subrev_u32 v19, 2, v19
    v_and_b32 v18, 7, v19
    v_lshlrev_b32 v18, 1, v18
    v_xor_b32 v18, v18, v11
    v_lshl_add_u32 v18, v19, 4, v18
    v_add_u32 v18, 64, v18
    v_lshlrev_b32 v236, 4, v18
    v_xor_b32 v237, 32, v236
    v_and_b32 v11, 1, v9
    v_lshlrev_b32 v11, 4, v11
    v_lshl_add_u32 v10, v10, 5, v11
    s_mul_i32 s60, s7, 3072
    s_add_u32 s60, s60, 135168
    v_add_u32 v63, s60, v10
    v_lshrrev_b32 v11, 1, v9
    v_lshlrev_b32 v11, 5, v11
    v_sub_u32 v61, v63, v11
    v_add_u32 v61, 32, v61
    v_add_u32 v63, 2048, v63
    s_sub_u32 s61, 63, s5
    s_lshl_b32 s86, s61, 6
    s_bfe_u32 s61, s61, 0x10002
    s_lshl_b32 s60, s7, 11
    s_add_u32 s60, s60, 122880
    v_and_b32 v10, 1, v9
    v_xor_b32 v10, s61, v10
    v_lshrrev_b32 v11, 1, v9
    v_xor_b32 v11, 1, v11
    v_lshl_add_u32 v10, v10, 1, v11
    v_bfe_u32 v11, v0, 1, 2
    v_xor_b32 v10, v10, v11
    v_lshl_add_u32 v10, v8, 2, v10
    v_lshl_add_u32 v71, v10, 4, s60
    v_bfe_u32 v10, v0, 3, 2
    v_xor_b32 v10, v10, v0
    v_lshl_add_u32 v72, v10, 4, s60
    v_lshrrev_b32 v10, 2, v0
    v_and_b32 v11, 3, v0
    v_lshlrev_b32 v10, 12, v10
    v_lshl_add_u32 v64, v11, 4, v10
    v_mul_u32_u24 v10, 2304, v9
    v_lshl_add_u32 v224, v8, 4, v10
    s_mul_i32 s87, s5, 73728
    s_mul_i32 s61, s7, 18432
    s_add_u32 s87, s87, s61
    s_add_u32 s88, s87, 9216
    s_lshl_b32 s61, s7, 11
    s_sub_u32 s89, s86, s61
    v_lshrrev_b32 v10, 1, v8
    v_lshl_add_u32 v79, v10, 6, s60
    v_lshrrev_b32 v10, 1, v9
    v_lshl_add_u32 v79, v10, 5, v79
    v_and_b32 v10, 1, v8
    v_lshl_add_u32 v79, v10, 4, v79
    v_and_b32 v10, 1, v9
    v_lshl_add_u32 v79, v10, 3, v79
    v_lshlrev_b32 v233, 3, v0
    v_lshlrev_b32 v231, 2, v0
    v_add_u32 v232, s60, v233
    v_lshlrev_b32 v65, 4, v0
    v_lshrrev_b32 v19, 1, v9
    v_mul_u32_u24 v19, 0x0202, v19
    v_add_u32 v19, 0x0100, v19
    v_lshl_or_b32 v19, v19, 16, v19
    s_or_b32 s60, s5, s7
    s_cmp_lg_u32 s60, 0
    s_cbranch_scc1 L_nogo
    v_mov_b32 v11, s63
    s_waitcnt vmcnt(10)
    buffer_store_dword v11, off, s[44:47], s90 sc1
L_nogo:
    s_waitcnt vmcnt(8)
    s_cmp_lt_u32 s7, 2
    s_cbranch_scc1 L_hw
    s_waitcnt vmcnt(5)
L_hw:
    v_mov_b32 v10, 141412
    v_mov_b32 v11, 1
    s_mov_b64 exec, 1
    ds_add_u32 v10, v11
    s_mov_b64 exec, -1
    s_waitcnt vmcnt(5)
    s_cmp_lt_u32 s7, 2
    s_cbranch_scc1 L_kw
    s_waitcnt vmcnt(2)
L_kw:
    v_mov_b32 v10, 141340
    v_mov_b32 v11, 1
    s_mov_b64 exec, 1
    ds_add_u32 v10, v11
    s_mov_b64 exec, -1
    v_perm_b32 v18, v12, v12, v19
    v_and_b32 v36, v18, v20
    v_and_b32 v37, v18, v21
    v_and_b32 v38, v18, v22
    v_and_b32 v39, v18, v23
    v_perm_b32 v18, v13, v13, v19
    v_and_b32 v40, v18, v20
    v_and_b32 v41, v18, v21
    v_and_b32 v42, v18, v22
    v_and_b32 v43, v18, v23
    v_perm_b32 v18, v14, v14, v19
    v_and_b32 v44, v18, v20
    v_and_b32 v45, v18, v21
    v_and_b32 v46, v18, v22
    v_and_b32 v47, v18, v23
    v_perm_b32 v18, v15, v15, v19
    v_and_b32 v48, v18, v20
    v_and_b32 v49, v18, v21
    v_and_b32 v50, v18, v22
    v_and_b32 v51, v18, v23
    v_perm_b32 v18, v16, v16, v19
    v_and_b32 v52, v18, v20
    v_and_b32 v53, v18, v21
    v_and_b32 v54, v18, v22
    v_and_b32 v55, v18, v23
    v_perm_b32 v18, v17, v17, v19
    v_and_b32 v56, v18, v20
    v_and_b32 v57, v18, v21
    v_and_b32 v58, v18, v22
    v_and_b32 v59, v18, v23
    v_mov_b32 v10, 141340
    s_mov_b32 s85, 2097152
L_wk0:
    ds_read_b32 v11, v10
    s_sub_u32 s85, s85, 1
    s_cbranch_scc1 L_end
    s_waitcnt lgkmcnt(0)
    v_readfirstlane_b32 s60, v11
    s_and_b32 s61, s60, 0xff
    s_cmp_ge_u32 s61, 4
    s_cbranch_scc0 L_wk0
    ds_read_b128 v[80:83], v234 offset:2048
    ds_read_b128 v[84:87], v236 offset:2048
    ds_read_b128 v[88:91], v234 offset:0
    ds_read_b128 v[92:95], v236 offset:0
    ds_read_b128 v[96:99], v235 offset:2048
    ds_read_b128 v[100:103], v237 offset:2048
    ds_read_b128 v[104:107], v235 offset:0
    ds_read_b128 v[108:111], v237 offset:0
    s_waitcnt lgkmcnt(6)
    v_mfma_f32_16x16x32_bf16 v[152:155], v[80:83], v[36:39], 0
    v_mfma_f32_16x16x32_bf16 v[152:155], v[84:87], v[40:43], v[152:155]
    s_waitcnt lgkmcnt(4)
    v_mfma_f32_16x16x32_bf16 v[156:159], v[88:91], v[36:39], 0
    v_mfma_f32_16x16x32_bf16 v[156:159], v[92:95], v[40:43], v[156:159]
    s_waitcnt lgkmcnt(2)
    v_mfma_f32_16x16x32_bf16 v[160:163], v[96:99], v[44:47], 0
    v_mfma_f32_16x16x32_bf16 v[160:163], v[100:103], v[48:51], v[160:163]
    s_waitcnt lgkmcnt(0)
    v_mfma_f32_16x16x32_bf16 v[164:167], v[104:107], v[44:47], 0
    v_mfma_f32_16x16x32_bf16 v[164:167], v[108:111], v[48:51], v[164:167]
    s_waitcnt vmcnt(0)
    v_mov_b32 v10, 141392
    v_mov_b32 v11, 1
    s_mov_b64 exec, 1
    ds_add_u32 v10, v11
    s_mov_b64 exec, -1
    v_mov_b32 v10, 141392
    s_mov_b32 s85, 2097152
L_wkv0:
    ds_read_b32 v11, v10
    s_sub_u32 s85, s85, 1
    s_cbranch_scc1 L_end
    s_waitcnt lgkmcnt(0)
    v_readfirstlane_b32 s60, v11
    s_and_b32 s61, s60, 0xff
    s_cmp_ge_u32 s61, 4
    s_cbranch_scc0 L_wkv0
    s_mul_i32 s38, s6, 1152
    s_add_u32 s38, s38, s56
    s_add_u32 s36, s20, s38
    s_addc_u32 s37, s21, 0
    s_sub_u32 s38, 4718592, s38
    s_mov_b32 s39, 0x00020000
    s_lshl_b32 s16, s4, 17
    s_add_u32 s16, s16, 0
    s_add_u32 s16, s24, s16
    s_addc_u32 s17, s25, 0
    s_mov_b32 s18, 131072
    s_mov_b32 s19, 0x00020000
    s_lshl_b32 s40, s4, 11
    s_add_u32 s40, s40, 16777216
    s_add_u32 s40, s24, s40
    s_addc_u32 s41, s25, 0
    s_mov_b32 s42, 2048
    s_mov_b32 s43, 0x00020000
    s_call_b64 s[0:1], L_p1_f
    buffer_load_dword v14, off, s[44:47], s90 sc1
    v_mov_b32 v10, 141424
    v_mov_b32 v11, 1
    s_mov_b64 exec, 1
    ds_add_u32 v10, v11
    s_mov_b64 exec, -1
    s_call_b64 s[0:1], L_su2
    s_waitcnt vmcnt(0)
    s_mov_b32 s85, 2097152
L_go:
    v_readfirstlane_b32 s61, v14
    s_cmp_lg_u32 s61, 0
    s_cbranch_scc1 L_go2
    buffer_load_dword v14, off, s[44:47], s90 sc1
    s_sub_u32 s85, s85, 1
    s_waitcnt vmcnt(0)
    s_cbranch_scc0 L_go
    s_endpgm
L_go2:
    s_cmp_eq_u32 s61, s63
    s_cbranch_scc1 L_gook
    v_mov_b32 v10, 1
    buffer_store_dword v10, off, s[44:47], s90 offset:32 sc1
    s_branch L_Hslow
L_gook:
    v_mov_b32 v10, 141428
    v_mov_b32 v11, 1
    s_mov_b64 exec, 1
    ds_add_rtn_u32 v12, v10, v11
    s_mov_b64 exec, -1
    v_mov_b32 v10, 1
    s_waitcnt lgkmcnt(0)
    v_readfirstlane_b32 s60, v12
    s_cmp_lg_u32 s60, 3
    s_cbranch_scc1 L_np0_f
    buffer_store_byte v10, off, s[40:43], s5
L_np0_f:
    s_mov_b32 s85, 2097152
    v_and_b32 v13, 28, v231
L_px0_f:
    buffer_load_dword v12, v13, s[40:43], 0 offen sc1
    buffer_load_dword v14, off, s[44:47], s90 offset:32 sc1
    s_sub_u32 s85, s85, 1
    s_cbranch_scc1 L_end
    s_waitcnt vmcnt(0)
    v_and_b32 v12, 16843009, v12
    v_readfirstlane_b32 s61, v14
    v_cmp_eq_u32 vcc, 16843009, v12
    s_cmp_lg_u32 s61, 0
    s_cbranch_scc1 L_Hslow
    s_cmp_eq_u64 vcc, exec
    s_cbranch_scc0 L_px0_f
    s_lshl_b32 s61, s7, 11
    s_add_u32 m0, s61, 108032
    s_add_u32 s60, s97, 2064384
    buffer_load_dwordx4 v225, s[36:39], s60 offen sc1 lds
    s_add_u32 m0, s61, 109056
    s_add_u32 s60, s97, 1769472
    buffer_load_dwordx4 v226, s[36:39], s60 offen sc1 lds
    s_lshl_b32 s60, s7, 10
    s_add_u32 m0, s60, 118272
    s_add_u32 s60, s60, s91
    buffer_load_dwordx4 v65, s[16:19], s60 offen sc1 lds
    v_mov_b32 v10, 141396
    v_mov_b32 v11, 1
    s_mov_b64 exec, 1
    s_waitcnt vmcnt(0)
    ds_add_u32 v10, v11
    s_mov_b64 exec, -1
    v_mov_b32 v10, 141396
    s_mov_b32 s85, 2097152
L_wx0_f:
    ds_read_b32 v11, v10
    s_sub_u32 s85, s85, 1
    s_cbranch_scc1 L_end
    s_waitcnt lgkmcnt(0)
    v_readfirstlane_b32 s60, v11
    s_and_b32 s61, s60, 0xff
    s_cmp_ge_u32 s61, 4
    s_cbranch_scc0 L_wx0_f
    s_add_u32 s58, s58, 1179648
    s_add_u32 s59, s59, 1179648
    s_add_u32 s86, s57, 1175040
    s_add_u32 m0, s62, 25600
    s_nop 0
    buffer_load_dwordx4 v2, s[28:31], s58 offen  lds
    s_add_u32 m0, s62, 29696
    s_nop 0
    buffer_load_dwordx4 v2, s[28:31], s59 offen  lds
    s_cmp_lg_u32 s7, 3
    s_cbranch_scc1 L_nh492
    s_mov_b32 m0, 24576
    s_nop 0
    buffer_load_dwordx4 v2, s[28:31], s86 offen  lds
L_nh492:
    s_add_u32 m0, s62, 36864
    s_nop 0
    buffer_load_dwordx4 v2, s[12:15], s58 offen  lds
    s_add_u32 m0, s62, 40960
    s_nop 0
    buffer_load_dwordx4 v2, s[12:15], s59 offen  lds
    s_add_u32 s87, s87, 2359296
    s_add_u32 s88, s88, 2359296
    s_branch L_hp2
.p2align 12
L_su2:
    v_bfe_u32 v10, v0, 2, 1
    v_lshlrev_b32 v10, 4, v10
    v_mov_b32 v11, 0x3f80
    v_lshlrev_b32 v10, v10, v11
    v_and_b32 v11, 3, v0
    v_sub_u32 v11, v11, v9
    v_bfe_u32 v18, v0, 3, 1
    v_lshl_add_u32 v11, v11, 1, v18
    v_cmp_eq_u32 vcc, 0, v11
    v_mov_b32 v30, 0
    v_mov_b32 v220, 0
    v_cndmask_b32 v28, 0, v10, vcc
    v_mov_b32 v222, v28
    v_cmp_eq_u32 vcc, 1, v11
    v_mov_b32 v31, 0
    v_mov_b32 v221, 0
    v_cndmask_b32 v29, 0, v10, vcc
    v_mov_b32 v223, v29
    v_bfe_u32 v10, v0, 1, 1
    v_lshlrev_b32 v10, 4, v10
    v_mov_b32 v11, 0x3f80
    v_lshlrev_b32 v10, v10, v11
    v_and_b32 v11, 1, v0
    v_sub_u32 v11, v11, v9
    v_lshrrev_b32 v18, 2, v8
    v_lshl_add_u32 v11, v11, 2, v18
    v_cmp_eq_u32 vcc, 0, v11
    s_nop 1
    v_cndmask_b32 v32, 0, v10, vcc
    v_cmp_eq_u32 vcc, 1, v11
    s_nop 1
    v_cndmask_b32 v33, 0, v10, vcc
    v_cmp_eq_u32 vcc, 2, v11
    s_nop 1
    v_cndmask_b32 v34, 0, v10, vcc
    v_cmp_eq_u32 vcc, 3, v11
    s_nop 1
    v_cndmask_b32 v35, 0, v10, vcc
    s_mul_i32 s60, s7, 3072
    v_and_b32 v10, 3, v0
    v_bfe_u32 v18, v0, 2, 1
    v_bfe_u32 v11, v0, 3, 1
    v_lshl_add_u32 v18, v18, 1, v11
    v_lshl_add_u32 v11, v9, 3, v10
    v_lshl_add_u32 v11, v11, 2, v18
    v_lshl_add_u32 v73, v11, 4, s60
    v_and_b32 v11, 1, v9
    v_lshl_add_u32 v11, v11, 3, v10
    v_lshl_add_u32 v11, v11, 2, v18
    s_add_u32 s60, s60, 2048
    v_lshl_add_u32 v74, v11, 4, s60
    v_lshrrev_b32 v18, 2, v8
    v_lshl_add_u32 v11, v9, 3, v18
    v_mul_u32_u24 v11, 1152, v11
    v_lshl_add_u32 v75, v10, 4, v11
    v_lshlrev_b32 v11, 1, v11
    v_lshl_add_u32 v77, v10, 4, v11
    v_lshrrev_b32 v11, 1, v8
    v_lshl_add_u32 v11, v9, 3, v11
    v_and_b32 v10, 1, v0
    v_mul_u32_u24 v11, 1152, v11
    v_lshl_add_u32 v76, v10, 4, v11
    s_cmp_eq_u32 s7, 3
    s_cselect_b32 s60, 0, 0x80000000
    v_or_b32 v76, s60, v76
    v_lshlrev_b32 v11, 1, v11
    v_lshl_add_u32 v78, v10, 4, v11
    s_and_b32 s91, s5, 15
    s_lshl_b32 s91, s91, 12
    v_lshlrev_b32 v10, 1, v9
    v_xor_b32 v10, v10, v8
    v_sub_u32 v11, 3, v9
    s_mov_b32 s60, 73728
    v_mul_lo_u32 v11, v11, s60
    v_lshl_add_u32 v225, v10, 4, v11
    v_xor_b32 v226, 128, v225
    s_mul_i32 s97, s5, 2304
    s_mul_i32 s60, s7, 589824
    s_sub_u32 s97, s97, s60
    v_lshrrev_b32 v10, 1, v0
    v_mul_u32_u24 v10, 2304, v10
    v_and_b32 v11, 1, v0
    v_lshl_add_u32 v10, v11, 7, v10
    s_mul_i32 s60, s7, 18432
    v_add_u32 v10, s60, v10
    v_cmp_gt_u32 vcc, 16, v0
    v_bfrev_b32 v18, 1
    s_nop 0
    v_cndmask_b32 v241, v18, v10, vcc
    s_lshr_b32 s60, s5, 4
    s_lshl_b32 s60, s60, 2
    s_add_u32 s60, s60, s7
    s_lshl_b32 s60, s60, 9
    s_add_u32 s60, s60, s91
    s_add_u32 s60, s60, 65536
    v_lshl_add_u32 v10, v0, 7, s60
    v_cmp_gt_u32 vcc, 4, v0
    s_nop 1
    v_cndmask_b32 v243, v18, v10, vcc
    s_mul_i32 s92, s5, 32*2304
    s_mul_i32 s93, s6, 1152
    s_add_u32 s92, s92, s93
    s_add_u32 s93, s92, s101
    s_lshl_b32 s94, s7, 6
    s_add_u32 s92, s92, s94
    s_add_u32 s92, s92, s56
    s_setpc_b64 s[0:1]
L_hp2:
    s_waitcnt vmcnt(0)
    s_mul_i32 s60, s5, 73728
    s_add_u32 s60, s60, 2359296
    buffer_load_dword v242, v241, s[36:39], s60 offen sc1
    s_sub_u32 s60, s57, s56
    s_add_u32 s60, s60, s101
    buffer_load_dwordx4 v[212:215], v76, s[48:51], s60 offen
    s_add_u32 s60, s60, 1179648
    buffer_load_dwordx4 v[216:219], v76, s[48:51], s60 offen
    s_waitcnt vmcnt(3)
    v_mov_b32 v10, 141400
    v_mov_b32 v11, 1
    s_mov_b64 exec, 1
    ds_add_u32 v10, v11
    s_mov_b64 exec, -1
    v_mov_b32 v10, 141400
    s_mov_b32 s85, 2097152
L_wkv1_f:
    ds_read_b32 v11, v10
    s_sub_u32 s85, s85, 1
    s_cbranch_scc1 L_end
    s_waitcnt lgkmcnt(0)
    v_readfirstlane_b32 s60, v11
    s_and_b32 s61, s60, 0xff
    s_cmp_ge_u32 s61, 4
    s_cbranch_scc0 L_wkv1_f
    ds_read_b128 v[80:83], v234 offset:26624
    ds_read_b128 v[88:91], v238 offset:38912
    ds_read_b128 v[84:87], v236 offset:26624
    ds_read_b128 v[92:95], v234 offset:24576
    ds_read_b128 v[100:103], v238 offset:36864
    ds_read_b128 v[96:99], v236 offset:24576
    ds_read_b128 v[104:107], v235 offset:26624
    ds_read_b128 v[112:115], v239 offset:38912
    ds_read_b128 v[108:111], v237 offset:26624
    ds_read_b128 v[116:119], v235 offset:24576
    ds_read_b128 v[124:127], v239 offset:36864
    ds_read_b128 v[120:123], v237 offset:24576
    s_waitcnt lgkmcnt(9)
    v_mfma_f32_16x16x32_bf16 v[152:155], v[80:83], v[36:39], 0
    v_mfma_f32_16x16x32_bf16 v[156:159], v[88:91], v[24:27], 0
    v_mfma_f32_16x16x32_bf16 v[152:155], v[84:87], v[40:43], v[152:155]
    s_waitcnt lgkmcnt(6)
    v_mfma_f32_16x16x32_bf16 v[160:163], v[92:95], v[36:39], 0
    v_mfma_f32_16x16x32_bf16 v[164:167], v[100:103], v[24:27], 0
    v_mfma_f32_16x16x32_bf16 v[160:163], v[96:99], v[40:43], v[160:163]
    s_waitcnt lgkmcnt(3)
    v_mfma_f32_16x16x32_bf16 v[168:171], v[104:107], v[44:47], 0
    s_nop 1
    v_mul_f32 v152, v152, v156
    v_mul_f32 v153, v153, v157
    v_mul_f32 v154, v154, v158
    v_mul_f32 v155, v155, v159
    v_mfma_f32_16x16x32_bf16 v[172:175], v[112:115], v[24:27], 0
    v_cvt_pk_bf16_f32 v176, v152, v153
    v_cvt_pk_bf16_f32 v177, v154, v155
    v_mfma_f32_16x16x32_bf16 v[168:171], v[108:111], v[48:51], v[168:171]
    s_waitcnt lgkmcnt(0)
    v_mfma_f32_16x16x32_bf16 v[152:155], v[116:119], v[44:47], 0
    v_mul_f32 v160, v160, v164
    v_mul_f32 v161, v161, v165
    v_mul_f32 v162, v162, v166
    v_mul_f32 v163, v163, v167
    v_mfma_f32_16x16x32_bf16 v[156:159], v[124:127], v[24:27], 0
    v_cvt_pk_bf16_f32 v178, v160, v161
    v_cvt_pk_bf16_f32 v179, v162, v163
    v_mfma_f32_16x16x32_bf16 v[152:155], v[120:123], v[48:51], v[152:155]
    ds_write_b128 v71, v[176:179] offset:0
    ds_read_b128 v[184:187], v72 offset:0
    v_mul_f32 v168, v168, v172
    v_mul_f32 v169, v169, v173
    v_mul_f32 v170, v170, v174
    v_mul_f32 v171, v171, v175
    v_cvt_pk_bf16_f32 v180, v168, v169
    v_cvt_pk_bf16_f32 v181, v170, v171
    s_waitcnt lgkmcnt(0)
    buffer_store_dwordx4 v[184:187], v224, s[36:39], s87 offen
    s_nop 1
    v_mul_f32 v152, v152, v156
    v_mul_f32 v153, v153, v157
    v_mul_f32 v154, v154, v158
    v_mul_f32 v155, v155, v159
    v_cvt_pk_bf16_f32 v182, v152, v153
    v_cvt_pk_bf16_f32 v183, v154, v155
    ds_write_b128 v71, v[180:183] offset:1024
    ds_read_b128 v[188:191], v72 offset:1024
    s_waitcnt lgkmcnt(0)
    buffer_store_dwordx4 v[188:191], v224, s[36:39], s88 offen
    s_waitcnt vmcnt(0)
    v_mov_b32 v10, 141432
    v_mov_b32 v11, 1
    s_mov_b64 exec, 1
    ds_add_rtn_u32 v12, v10, v11
    s_mov_b64 exec, -1
    v_mov_b32 v10, 3
    s_waitcnt lgkmcnt(0)
    v_readfirstlane_b32 s60, v12
    s_cmp_lg_u32 s60, 3
    s_cbranch_scc1 L_np1_f
    buffer_store_byte v10, off, s[40:43], s5
L_np1_f:
    s_lshl_b32 s95, s5, 6
    s_mul_i32 s99, s7, 3072
    s_mov_b32 s85, 2097152
    v_and_b32 v13, 28, v231
L_px1_f:
    buffer_load_dword v12, v13, s[40:43], 0 offen sc1
    s_sub_u32 s85, s85, 1
    s_cbranch_scc1 L_end
    s_waitcnt vmcnt(0)
    v_and_b32 v12, 33686018, v12
    v_cmp_eq_u32 vcc, 33686018, v12
    s_cmp_eq_u64 vcc, exec
    s_cbranch_scc0 L_px1_f
    s_lshl_b32 s61, s7, 11
    s_add_u32 m0, s61, 99840
    s_add_u32 s60, s97, 4423680
    buffer_load_dwordx4 v225, s[36:39], s60 offen sc1 lds
    s_add_u32 m0, s61, 100864
    s_add_u32 s60, s97, 4128768
    buffer_load_dwordx4 v226, s[36:39], s60 offen sc1 lds
    s_waitcnt vmcnt(0)
    v_mov_b32 v10, 141404
    v_mov_b32 v11, 1
    s_mov_b64 exec, 1
    ds_add_u32 v10, v11
    s_mov_b64 exec, -1
    v_mov_b32 v10, 141404
    s_mov_b32 s85, 2097152
L_wx1_f:
    ds_read_b32 v11, v10
    s_sub_u32 s85, s85, 1
    s_cbranch_scc1 L_end
    s_waitcnt lgkmcnt(0)
    v_readfirstlane_b32 s60, v11
    s_and_b32 s61, s60, 0xff
    s_cmp_ge_u32 s61, 4
    s_cbranch_scc0 L_wx1_f
    s_lshl_b32 s60, s7, 6
    s_add_u32 s61, s57, 0
    s_add_u32 s60, s60, s61
    buffer_load_dwordx4 v[196:199], v75, s[48:51], s60 offen
    s_add_u32 s60, s60, 4608
    buffer_load_dwordx4 v[200:203], v75, s[48:51], s60 offen
    s_lshl_b32 s60, s7, 6
    s_add_u32 s61, s57, 1179648
    s_add_u32 s60, s60, s61
    buffer_load_dwordx4 v[204:207], v75, s[48:51], s60 offen
    s_add_u32 s60, s60, 4608
    buffer_load_dwordx4 v[208:211], v75, s[48:51], s60 offen
    s_cmp_lg_u32 s7, 3
    s_cbranch_scc1 L_np3x3_f
    v_lshlrev_b32 v120, 16, v212
    v_and_b32 v121, 0xffff0000, v212
    v_lshlrev_b32 v122, 16, v213
    v_and_b32 v123, 0xffff0000, v213
    v_lshlrev_b32 v124, 16, v214
    v_and_b32 v125, 0xffff0000, v214
    v_lshlrev_b32 v126, 16, v215
    v_and_b32 v127, 0xffff0000, v215
    v_lshlrev_b32 v128, 16, v216
    v_and_b32 v129, 0xffff0000, v216
    v_lshlrev_b32 v130, 16, v217
    v_and_b32 v131, 0xffff0000, v217
    v_lshlrev_b32 v132, 16, v218
    v_and_b32 v133, 0xffff0000, v218
    v_lshlrev_b32 v134, 16, v219
    v_and_b32 v135, 0xffff0000, v219
    s_mov_b32 s85, 2097152
L_py5_f:
    buffer_load_dwordx2 v[12:13], v233, s[40:43], 0 offen offset:1024 sc1
    s_sub_u32 s85, s85, 1
    s_cbranch_scc1 L_end
    s_waitcnt vmcnt(0)
    v_min_u32 v12, v12, v13
    v_cmp_le_u32 vcc, 1, v12
    s_cmp_eq_u64 vcc, exec
    s_cbranch_scc0 L_py5_f
    s_add_u32 m0, s99, 2048
    s_add_u32 s61, s95, 67584
    buffer_load_dwordx4 v64, s[16:19], s61 offen sc1 lds
    s_add_u32 m0, s99, 14336
    s_add_u32 s61, s95, 65536
    buffer_load_dwordx4 v64, s[16:19], s61 offen sc1 lds
    s_waitcnt vmcnt(0)
    ds_read_b128 v[80:83], v74 offset:0
    ds_read_b128 v[84:87], v74 offset:256
    ds_read_b128 v[88:91], v74 offset:12288
    ds_read_b128 v[92:95], v74 offset:12544
    s_waitcnt lgkmcnt(0)
    v_mfma_f32_16x16x32_bf16 v[96:99], v[80:83], v[32:35], 0
    v_mfma_f32_16x16x32_bf16 v[100:103], v[84:87], v[32:35], 0
    v_mfma_f32_16x16x32_bf16 v[104:107], v[88:91], v[32:35], 0
    v_mfma_f32_16x16x32_bf16 v[108:111], v[92:95], v[32:35], 0
    s_nop 5
    v_mul_f32 v96, v96, v120
    v_mul_f32 v97, v97, v121
    v_mul_f32 v98, v98, v122
    v_mul_f32 v99, v99, v123
    v_mul_f32 v100, v100, v124
    v_mul_f32 v101, v101, v125
    v_mul_f32 v102, v102, v126
    v_mul_f32 v103, v103, v127
    s_add_u32 s61, s93, 0
    v_cvt_pk_bf16_f32 v52, v96, v97
    v_cvt_pk_bf16_f32 v53, v98, v99
    v_cvt_pk_bf16_f32 v54, v100, v101
    v_cvt_pk_bf16_f32 v55, v102, v103
    buffer_store_dwordx4 v[52:55], v78, s[52:55], s61 offen nt
    v_mul_f32 v104, v104, v128
    v_mul_f32 v105, v105, v129
    v_mul_f32 v106, v106, v130
    v_mul_f32 v107, v107, v131
    v_mul_f32 v108, v108, v132
    v_mul_f32 v109, v109, v133
    v_mul_f32 v110, v110, v134
    v_mul_f32 v111, v111, v135
    s_add_u32 s61, s93, 2359296
    v_cvt_pk_bf16_f32 v56, v104, v105
    v_cvt_pk_bf16_f32 v57, v106, v107
    v_cvt_pk_bf16_f32 v58, v108, v109
    v_cvt_pk_bf16_f32 v59, v110, v111
    buffer_store_dwordx4 v[56:59], v78, s[52:55], s61 offen nt
L_np3x3_f:
    s_waitcnt vmcnt(2)
    s_cmp_eq_u32 s7, 3
    s_cbranch_scc1 L_q3_f
    s_waitcnt vmcnt(0)
L_q3_f:
    v_lshlrev_b32 v144, 16, v196
    v_and_b32 v145, 0xffff0000, v196
    v_lshlrev_b32 v146, 16, v197
    v_and_b32 v147, 0xffff0000, v197
    v_lshlrev_b32 v148, 16, v198
    v_and_b32 v149, 0xffff0000, v198
    v_lshlrev_b32 v150, 16, v199
    v_and_b32 v151, 0xffff0000, v199
    v_lshlrev_b32 v152, 16, v200
    v_and_b32 v153, 0xffff0000, v200
    v_lshlrev_b32 v154, 16, v201
    v_and_b32 v155, 0xffff0000, v201
    v_lshlrev_b32 v156, 16, v202
    v_and_b32 v157, 0xffff0000, v202
    v_lshlrev_b32 v158, 16, v203
    v_and_b32 v159, 0xffff0000, v203
    v_lshlrev_b32 v160, 16, v204
    v_and_b32 v161, 0xffff0000, v204
    v_lshlrev_b32 v162, 16, v205
    v_and_b32 v163, 0xffff0000, v205
    v_lshlrev_b32 v164, 16, v206
    v_and_b32 v165, 0xffff0000, v206
    v_lshlrev_b32 v166, 16, v207
    v_and_b32 v167, 0xffff0000, v207
    v_lshlrev_b32 v168, 16, v208
    v_and_b32 v169, 0xffff0000, v208
    v_lshlrev_b32 v170, 16, v209
    v_and_b32 v171, 0xffff0000, v209
    v_lshlrev_b32 v172, 16, v210
    v_and_b32 v173, 0xffff0000, v210
    v_lshlrev_b32 v174, 16, v211
    v_and_b32 v175, 0xffff0000, v211
    s_mov_b32 s85, 2097152
L_py_f:
    buffer_load_dwordx2 v[12:13], v233, s[40:43], 0 offen offset:512 sc1
    s_sub_u32 s85, s85, 1
    s_cbranch_scc1 L_end
    s_waitcnt vmcnt(0)
    v_min_u32 v12, v12, v13
    v_cmp_le_u32 vcc, 2, v12
    s_cmp_eq_u64 vcc, exec
    s_cbranch_scc0 L_py_f
    s_add_u32 m0, s99, 0
    s_sub_u32 s61, s87, 2359296
    buffer_load_dwordx4 v224, s[36:39], s61 offen sc1 lds
    s_add_u32 m0, s99, 1024
    s_sub_u32 s61, s88, 2359296
    buffer_load_dwordx4 v224, s[36:39], s61 offen sc1 lds
    s_add_u32 m0, s99, 12288
    s_sub_u32 s61, s87, 0
    buffer_load_dwordx4 v224, s[36:39], s61 offen sc1 lds
    s_add_u32 m0, s99, 13312
    s_sub_u32 s61, s88, 0
    buffer_load_dwordx4 v224, s[36:39], s61 offen sc1 lds
    s_waitcnt vmcnt(2)
    ds_read_b128 v[80:83], v73 offset:0
    ds_read_b128 v[84:87], v73 offset:256
    s_waitcnt vmcnt(0)
    ds_read_b128 v[88:91], v73 offset:12288
    ds_read_b128 v[92:95], v73 offset:12544
    s_waitcnt lgkmcnt(3)
    v_mfma_f32_16x16x32_bf16 v[96:99], v[80:83], v[28:31], 0
    s_waitcnt lgkmcnt(2)
    v_mfma_f32_16x16x32_bf16 v[100:103], v[84:87], v[28:31], 0
    v_mfma_f32_16x16x32_bf16 v[104:107], v[80:83], v[220:223], 0
    v_mfma_f32_16x16x32_bf16 v[108:111], v[84:87], v[220:223], 0
    s_waitcnt lgkmcnt(1)
    v_mfma_f32_16x16x32_bf16 v[112:115], v[88:91], v[28:31], 0
    s_waitcnt lgkmcnt(0)
    v_mfma_f32_16x16x32_bf16 v[116:119], v[92:95], v[28:31], 0
    v_mfma_f32_16x16x32_bf16 v[120:123], v[88:91], v[220:223], 0
    v_mfma_f32_16x16x32_bf16 v[124:127], v[92:95], v[220:223], 0
    s_nop 1
    v_pk_mul_f32 v[96:97], v[96:97], v[144:145]
    v_pk_mul_f32 v[98:99], v[98:99], v[146:147]
    v_pk_mul_f32 v[100:101], v[100:101], v[148:149]
    v_pk_mul_f32 v[102:103], v[102:103], v[150:151]
    s_add_u32 s61, s92, 0
    v_cvt_pk_bf16_f32 v36, v96, v97
    v_cvt_pk_bf16_f32 v37, v98, v99
    v_cvt_pk_bf16_f32 v38, v100, v101
    v_cvt_pk_bf16_f32 v39, v102, v103
    s_barrier
    buffer_store_dwordx4 v[36:39], v77, s[52:55], s61 offen
    v_pk_mul_f32 v[104:105], v[104:105], v[152:153]
    v_pk_mul_f32 v[106:107], v[106:107], v[154:155]
    v_pk_mul_f32 v[108:109], v[108:109], v[156:157]
    v_pk_mul_f32 v[110:111], v[110:111], v[158:159]
    s_add_u32 s61, s92, 9216
    v_cvt_pk_bf16_f32 v40, v104, v105
    v_cvt_pk_bf16_f32 v41, v106, v107
    v_cvt_pk_bf16_f32 v42, v108, v109
    v_cvt_pk_bf16_f32 v43, v110, v111
    buffer_store_dwordx4 v[40:43], v77, s[52:55], s61 offen
    v_pk_mul_f32 v[112:113], v[112:113], v[160:161]
    v_pk_mul_f32 v[114:115], v[114:115], v[162:163]
    v_pk_mul_f32 v[116:117], v[116:117], v[164:165]
    v_pk_mul_f32 v[118:119], v[118:119], v[166:167]
    s_add_u32 s61, s92, 2359296
    v_cvt_pk_bf16_f32 v44, v112, v113
    v_cvt_pk_bf16_f32 v45, v114, v115
    v_cvt_pk_bf16_f32 v46, v116, v117
    v_cvt_pk_bf16_f32 v47, v118, v119
    buffer_store_dwordx4 v[44:47], v77, s[52:55], s61 offen
    v_pk_mul_f32 v[120:121], v[120:121], v[168:169]
    v_pk_mul_f32 v[122:123], v[122:123], v[170:171]
    v_pk_mul_f32 v[124:125], v[124:125], v[172:173]
    v_pk_mul_f32 v[126:127], v[126:127], v[174:175]
    s_add_u32 s61, s92, 2368512
    v_cvt_pk_bf16_f32 v48, v120, v121
    v_cvt_pk_bf16_f32 v49, v122, v123
    v_cvt_pk_bf16_f32 v50, v124, v125
    v_cvt_pk_bf16_f32 v51, v126, v127
    buffer_store_dwordx4 v[48:51], v77, s[52:55], s61 offen
    s_endpgm
T_p1_f:
    s_setpc_b64 s[0:1]
L_p1_f:
    s_cmp_lt_u32 s7, 2
    s_cbranch_scc1 L_p1x_f
    ds_read_b128 v[80:83], v238 offset:14336
    ds_read_b128 v[84:87], v238 offset:12288
    ds_read_b128 v[88:91], v239 offset:14336
    ds_read_b128 v[92:95], v239 offset:12288
    s_waitcnt lgkmcnt(3)
    v_mfma_f32_16x16x32_bf16 v[104:107], v[80:83], v[24:27], 0
    s_waitcnt lgkmcnt(2)
    v_mfma_f32_16x16x32_bf16 v[108:111], v[84:87], v[24:27], 0
    s_waitcnt lgkmcnt(1)
    v_mfma_f32_16x16x32_bf16 v[112:115], v[88:91], v[24:27], 0
    s_waitcnt lgkmcnt(0)
    v_mfma_f32_16x16x32_bf16 v[116:119], v[92:95], v[24:27], 0
    s_nop 1
    v_mul_f32 v104, v104, v152
    v_mul_f32 v105, v105, v153
    v_mul_f32 v106, v106, v154
    v_mul_f32 v107, v107, v155
    v_cvt_pk_bf16_f32 v128, v104, v105
    v_cvt_pk_bf16_f32 v129, v106, v107
    v_mul_f32 v108, v108, v156
    v_mul_f32 v109, v109, v157
    v_mul_f32 v110, v110, v158
    v_mul_f32 v111, v111, v159
    v_cvt_pk_bf16_f32 v130, v108, v109
    v_cvt_pk_bf16_f32 v131, v110, v111
    ds_write_b128 v71, v[128:131] offset:0
    ds_read_b128 v[176:179], v72 offset:0
    v_mul_f32 v112, v112, v160
    v_mul_f32 v113, v113, v161
    v_mul_f32 v114, v114, v162
    v_mul_f32 v115, v115, v163
    v_cvt_pk_bf16_f32 v132, v112, v113
    v_cvt_pk_bf16_f32 v133, v114, v115
    v_mul_f32 v116, v116, v164
    v_mul_f32 v117, v117, v165
    v_mul_f32 v118, v118, v166
    v_mul_f32 v119, v119, v167
    v_cvt_pk_bf16_f32 v134, v116, v117
    v_cvt_pk_bf16_f32 v135, v118, v119
    ds_write_b128 v71, v[132:135] offset:1024
    ds_read_b128 v[180:183], v72 offset:1024
    s_waitcnt lgkmcnt(2)
    buffer_store_dwordx4 v[176:179], v224, s[36:39], s87 offen
    s_waitcnt lgkmcnt(0)
    buffer_store_dwordx4 v[180:183], v224, s[36:39], s88 offen
    s_setpc_b64 s[0:1]
T_p1x_f:
    s_setpc_b64 s[0:1]
L_p1x_f:
    ds_read_b128 v[80:83], v238 offset:14336
    ds_read_b128 v[84:87], v238 offset:12288
    ds_read_b128 v[88:91], v239 offset:14336
    ds_read_b128 v[92:95], v239 offset:12288
    ds_read_b128 v[96:99], v63 offset:256
    ds_read_b128 v[100:103], v63 offset:0
    ds_read_b128 v[188:191], v61 offset:320
    ds_read_b128 v[192:195], v61 offset:256
    ds_read_b128 v[196:199], v61 offset:64
    ds_read_b128 v[200:203], v61 offset:0
    s_waitcnt lgkmcnt(9)
    v_mfma_f32_16x16x32_bf16 v[104:107], v[80:83], v[24:27], 0
    s_waitcnt lgkmcnt(8)
    v_mfma_f32_16x16x32_bf16 v[108:111], v[84:87], v[24:27], 0
    s_waitcnt lgkmcnt(7)
    v_mfma_f32_16x16x32_bf16 v[112:115], v[88:91], v[24:27], 0
    s_waitcnt lgkmcnt(6)
    v_mfma_f32_16x16x32_bf16 v[116:119], v[92:95], v[24:27], 0
    s_waitcnt lgkmcnt(5)
    v_mfma_f32_16x16x32_bf16 v[120:123], v[96:99], v[24:27], 0
    s_waitcnt lgkmcnt(4)
    v_mfma_f32_16x16x32_bf16 v[124:127], v[100:103], v[24:27], 0
    s_waitcnt lgkmcnt(2)
    v_mfma_f32_16x16x32_bf16 v[168:171], v[188:191], v[52:55], 0
    v_mfma_f32_16x16x32_bf16 v[168:171], v[192:195], v[56:59], v[168:171]
    s_waitcnt lgkmcnt(0)
    v_mfma_f32_16x16x32_bf16 v[172:175], v[196:199], v[52:55], 0
    v_mfma_f32_16x16x32_bf16 v[172:175], v[200:203], v[56:59], v[172:175]
    v_mul_f32 v104, v104, v152
    v_mul_f32 v105, v105, v153
    v_mul_f32 v106, v106, v154
    v_mul_f32 v107, v107, v155
    v_cvt_pk_bf16_f32 v128, v104, v105
    v_cvt_pk_bf16_f32 v129, v106, v107
    v_mul_f32 v108, v108, v156
    v_mul_f32 v109, v109, v157
    v_mul_f32 v110, v110, v158
    v_mul_f32 v111, v111, v159
    v_cvt_pk_bf16_f32 v130, v108, v109
    v_cvt_pk_bf16_f32 v131, v110, v111
    ds_write_b128 v71, v[128:131] offset:0
    ds_read_b128 v[176:179], v72 offset:0
    v_mul_f32 v112, v112, v160
    v_mul_f32 v113, v113, v161
    v_mul_f32 v114, v114, v162
    v_mul_f32 v115, v115, v163
    v_cvt_pk_bf16_f32 v132, v112, v113
    v_cvt_pk_bf16_f32 v133, v114, v115
    v_mul_f32 v116, v116, v164
    v_mul_f32 v117, v117, v165
    v_mul_f32 v118, v118, v166
    v_mul_f32 v119, v119, v167
    v_cvt_pk_bf16_f32 v134, v116, v117
    v_cvt_pk_bf16_f32 v135, v118, v119
    ds_write_b128 v71, v[132:135] offset:1024
    ds_read_b128 v[180:183], v72 offset:1024
    s_waitcnt lgkmcnt(2)
    buffer_store_dwordx4 v[176:179], v224, s[36:39], s87 offen
    v_mul_f32 v120, v120, v168
    v_mul_f32 v121, v121, v169
    v_mul_f32 v122, v122, v170
    v_mul_f32 v123, v123, v171
    v_cvt_pk_bf16_f32 v136, v120, v121
    v_cvt_pk_bf16_f32 v137, v122, v123
    v_mul_f32 v124, v124, v172
    v_mul_f32 v125, v125, v173
    v_mul_f32 v126, v126, v174
    v_mul_f32 v127, v127, v175
    v_cvt_pk_bf16_f32 v138, v124, v125
    v_cvt_pk_bf16_f32 v139, v126, v127
    ds_write_b128 v71, v[136:139] offset:0
    ds_read_b128 v[184:187], v72 offset:0
    s_waitcnt lgkmcnt(2)
    buffer_store_dwordx4 v[180:183], v224, s[36:39], s88 offen
    s_waitcnt lgkmcnt(0)
    buffer_store_dwordx4 v[184:187], v64, s[16:19], s89 offen
    s_setpc_b64 s[0:1]
.p2align 12
L_M:
    s_waitcnt lgkmcnt(0)
    s_mul_i32 s38, s6, 1152
    s_add_u32 s38, s38, s56
    s_add_u32 s36, s20, s38
    s_addc_u32 s37, s21, 0
    s_sub_u32 s38, 4718592, s38
    s_mov_b32 s39, 0x00020000
    s_lshl_b32 s48, s4, 17
    s_add_u32 s48, s48, 0
    s_add_u32 s48, s24, s48
    s_addc_u32 s49, s25, 0
    s_mov_b32 s50, 131072
    s_mov_b32 s51, 0x00020000
    s_lshl_b32 s40, s4, 11
    s_add_u32 s40, s40, 16777216
    s_add_u32 s40, s24, s40
    s_addc_u32 s41, s25, 0
    s_mov_b32 s42, 2048
    s_mov_b32 s43, 0x00020000
    s_mov_b32 s32, s16
    s_mov_b32 s33, s17
    s_mov_b32 s34, 2359296
    s_mov_b32 s35, 0x00020000
    s_lshl_b32 s60, s5, 2
    s_add_u32 s60, s60, s7
    s_lshl_b32 s86, s60, 12
    s_lshr_b32 s61, s56, 1
    s_add_u32 s87, s61, s60
    s_and_b32 s88, s5, 15
    s_lshr_b32 s61, s101, 1
    s_add_u32 s88, s88, s61
    s_lshl_b32 s89, s87, 12
    s_lshl_b32 s90, s88, 12
    v_mov_b32 v10, 141412
    s_mov_b32 s85, 2097152
L_whg:
    ds_read_b32 v11, v10
    s_sub_u32 s85, s85, 1
    s_cbranch_scc1 L_end
    s_waitcnt lgkmcnt(0)
    v_readfirstlane_b32 s60, v11
    s_and_b32 s61, s60, 0xff
    s_cmp_ge_u32 s61, 4
    s_cbranch_scc0 L_whg
    v_lshrrev_b32 v10, 1, v0
    v_mul_u32_u24 v10, 2304, v10
    v_and_b32 v11, 1, v0
    v_lshl_add_u32 v10, v11, 7, v10
    s_mul_i32 s60, s5, 73728
    s_mul_i32 s61, s7, 18432
    s_add_u32 s60, s60, s61
    v_add_u32 v10, s60, v10
    v_cmp_gt_u32 vcc, 16, v0
    v_bfrev_b32 v12, 1
    s_lshl_b32 s60, s5, 12
    v_cndmask_b32 v15, v12, v10, vcc
    buffer_load_dword v201, v15, s[36:39], 0 offen sc1
    s_lshl_b32 s61, s7, 10
    s_add_u32 s60, s60, s61
    v_lshl_add_u32 v10, v0, 7, s60
    v_cmp_gt_u32 vcc, 8, v0
    s_nop 1
    v_cndmask_b32 v14, v12, v10, vcc
    buffer_load_dword v202, v14, s[48:51], 0 offen sc1
    v_lshlrev_b32 v1, 4, v0
    s_mul_i32 s91, s7, 8448
    s_add_u32 s91, s91, 49152
    s_add_u32 m0, s91, 32
    s_lshl_b32 s98, s7, 10
    buffer_load_dwordx4 v1, s[32:35], s89 offen offset:0  lds
    buffer_load_dwordx4 v1, s[32:35], s89 offen offset:1024  lds
    buffer_load_dwordx4 v1, s[32:35], s89 offen offset:2048  lds
    buffer_load_dwordx4 v1, s[32:35], s89 offen offset:3072  lds
    s_add_u32 s99, s90, s98
    s_add_u32 m0, s98, 82976
    s_nop 0
    buffer_load_dwordx4 v1, s[32:35], s99 offen  lds
    s_cmp_lg_u32 s7, 0
    s_cbranch_scc1 L_nt0
    s_call_b64 s[0:1], T_p1_f
L_nt0:
    s_cmp_lg_u32 s7, 1
    s_cbranch_scc1 L_nt1
    s_call_b64 s[0:1], T_p1x_f
L_nt1:
    s_load_dword s92, s[16:17], s89
    s_load_dword s93, s[16:17], s90
    s_lshl_b32 s60, s87, 1
    s_and_b32 s60, s60, -4
    s_lshl_b32 s61, s88, 1
    s_and_b32 s61, s61, -4
    s_load_dword s94, s[18:19], s60
    s_load_dword s95, s[18:19], s61
    v_and_b32 v8, 15, v0
    v_lshrrev_b32 v9, 4, v0
    v_and_b32 v11, 1, v0
    v_lshlrev_b32 v11, 4, v11
    v_bfe_u32 v12, v0, 1, 1
    v_mul_u32_u24 v12, 4224, v12
    v_add_u32 v11, v11, v12
    s_lshl_b32 s60, s7, 9
    s_add_u32 s60, s60, 116224
    v_add_u32 v12, s60, v1
    v_add_u32 v13, s91, v11
    v_add_u32 v10, 122368, v1
    v_bfe_u32 v11, v0, 1, 2
    v_mul_u32_u24 v11, 4224, v11
    v_and_b32 v14, 16, v1
    v_add_u32 v11, 82944, v11
    v_add_u32 v11, v14, v11
    v_cmp_gt_u32 vcc, 32, v0
    v_mov_b32 v28, 0
    v_mov_b32 v29, 0
    v_mov_b32 v30, 0
    v_mov_b32 v31, 0
    v_cndmask_b32 v12, v13, v12, vcc
    v_cndmask_b32 v10, v11, v10, vcc
    ds_write_b128 v12, v[28:31]
    s_cmp_lg_u32 s7, 0
    s_cbranch_scc1 L_nz5
    ds_write_b128 v10, v[28:31]
L_nz5:
    s_mov_b32 s52, 118272
    s_and_b32 s53, s7, 1
    s_lshl_b32 s53, s53, 1
    s_lshl_b32 s54, s7, 2
    v_bfe_u32 v10, v0, 2, 2
    v_and_b32 v11, 3, v0
    v_add_u32 v2, 1, v10
    v_lshrrev_b32 v2, 1, v2
    v_add_u32 v2, v2, v11
    v_lshl_add_u32 v2, v9, 2, v2
    v_lshlrev_b32 v2, 3, v2
    v_and_b32 v10, 1, v10
    v_xor_b32 v10, 1, v10
    v_mul_u32_u24 v10, 4224, v10
    v_add3_u32 v2, v2, v10, s91
    v_sub_u32 v10, v9, v8
    v_add_u32 v10, 15, v10
    v_lshrrev_b32 v11, 1, v10
    v_lshl_add_u32 v242, v11, 6, s52
    v_bfe_u32 v18, v10, 3, 1
    v_and_b32 v10, 1, v10
    v_lshl_add_u32 v10, v18, 1, v10
    v_xor_b32 v18, s53, v10
    v_lshl_add_u32 v242, v18, 4, v242
    v_and_b32 v18, 7, v11
    v_lshlrev_b32 v18, 1, v18
    v_xor_b32 v10, v10, v18
    v_xor_b32 v10, s54, v10
    v_lshl_add_u32 v10, v11, 4, v10
    v_lshlrev_b32 v10, 4, v10
    v_add_u32 v246, 99840, v10
    v_xor_b32 v10, 32, v10
    v_add_u32 v247, 99840, v10
    v_sub_u32 v10, v9, v8
    v_add_u32 v10, 19, v10
    v_lshrrev_b32 v11, 1, v10
    v_lshl_add_u32 v243, v11, 6, s52
    v_bfe_u32 v18, v10, 3, 1
    v_and_b32 v10, 1, v10
    v_lshl_add_u32 v10, v18, 1, v10
    v_xor_b32 v18, s53, v10
    v_lshl_add_u32 v243, v18, 4, v243
    v_and_b32 v18, 7, v11
    v_lshlrev_b32 v18, 1, v18
    v_xor_b32 v10, v10, v18
    v_xor_b32 v10, s54, v10
    v_lshl_add_u32 v10, v11, 4, v10
    v_lshlrev_b32 v10, 4, v10
    v_add_u32 v248, 99840, v10
    v_xor_b32 v10, 32, v10
    v_add_u32 v249, 99840, v10
    v_sub_u32 v10, v9, v8
    v_add_u32 v10, 23, v10
    v_lshrrev_b32 v11, 1, v10
    v_lshl_add_u32 v244, v11, 6, s52
    v_bfe_u32 v18, v10, 3, 1
    v_and_b32 v10, 1, v10
    v_lshl_add_u32 v10, v18, 1, v10
    v_xor_b32 v18, s53, v10
    v_lshl_add_u32 v244, v18, 4, v244
    v_and_b32 v18, 7, v11
    v_lshlrev_b32 v18, 1, v18
    v_xor_b32 v10, v10, v18
    v_xor_b32 v10, s54, v10
    v_lshl_add_u32 v10, v11, 4, v10
    v_lshlrev_b32 v10, 4, v10
    v_add_u32 v250, 99840, v10
    v_xor_b32 v10, 32, v10
    v_add_u32 v251, 99840, v10
    v_sub_u32 v10, v9, v8
    v_add_u32 v10, 27, v10
    v_lshrrev_b32 v11, 1, v10
    v_lshl_add_u32 v245, v11, 6, s52
    v_bfe_u32 v18, v10, 3, 1
    v_and_b32 v10, 1, v10
    v_lshl_add_u32 v10, v18, 1, v10
    v_xor_b32 v18, s53, v10
    v_lshl_add_u32 v245, v18, 4, v245
    v_and_b32 v18, 7, v11
    v_lshlrev_b32 v18, 1, v18
    v_xor_b32 v10, v10, v18
    v_xor_b32 v10, s54, v10
    v_lshl_add_u32 v10, v11, 4, v10
    v_lshlrev_b32 v10, 4, v10
    v_add_u32 v252, 99840, v10
    v_xor_b32 v10, 32, v10
    v_add_u32 v253, 99840, v10
    v_subrev_u32 v4, 16, v0
    v_add_u32 v10, 47, v0
    v_cmp_gt_u32 vcc, 16, v0
    v_mov_b32 v11, 63
    s_nop 0
    v_cndmask_b32 v4, v4, v10, vcc
    v_cmp_eq_u32 vcc, 0, v0
    s_nop 1
    v_cndmask_b32 v4, v4, v11, vcc
    v_lshlrev_b32 v4, 2, v4
    v_cmp_eq_u32 vcc, 63, v0
    s_nop 1
    v_cndmask_b32 v5, 0, -1, vcc
    v_lshrrev_b32 v10, 1, v9
    v_and_b32 v11, 1, v8
    v_lshl_add_u32 v10, v10, 1, v11
    v_lshlrev_b32 v10, 4, v10
    v_lshrrev_b32 v11, 1, v8
    v_lshl_add_u32 v255, v11, 6, v10
    v_and_b32 v14, 1, v9
    v_lshl_add_u32 v255, v14, 3, v255
    v_lshl_add_u32 v11, v14, 3, v11
    s_mov_b32 s60, 73728
    v_mul_lo_u32 v11, v11, s60
    s_mul_i32 s60, s5, 2304
    s_lshl_b32 s61, s7, 6
    s_add_u32 s60, s60, s61
    v_add3_u32 v6, v11, v10, s60
    s_mov_b32 s52, 0
    s_mov_b32 s53, 1179648
    s_mov_b32 s54, 2359296
    s_mov_b32 s55, 3538944
    s_waitcnt lgkmcnt(0)
    s_and_b32 s60, s87, 1
    s_lshl_b32 s60, s60, 4
    s_lshr_b32 s94, s94, s60
    s_lshl_b32 s94, s94, 16
    s_lshl_b32 s60, s92, 16
    s_and_b32 s92, s92, 0xffff0000
    v_mov_b32 v10, s60
    v_add_f32 v10, s94, v10
    v_mov_b32 v11, s92
    v_cvt_pk_bf16_f32 v12, v10, v11
    s_and_b32 s60, s88, 1
    s_lshl_b32 s60, s60, 4
    s_lshr_b32 s95, s95, s60
    s_lshl_b32 s95, s95, 16
    s_lshl_b32 s60, s93, 16
    s_and_b32 s93, s93, 0xffff0000
    v_mov_b32 v10, s60
    v_add_f32 v10, s95, v10
    v_mov_b32 v11, s93
    v_cvt_pk_bf16_f32 v13, v10, v11
    v_and_b32 v11, 2, v0
    v_lshlrev_b32 v11, 3, v11
    v_lshlrev_b32 v13, v11, v13
    v_and_b32 v11, 3, v0
    v_mul_u32_u24 v11, 4224, v11
    v_and_b32 v14, 1, v0
    v_lshlrev_b32 v14, 2, v14
    v_sub_u32 v11, v11, v14
    v_add_u32 v11, 82944, v11
    v_mov_b32 v10, s91
    ds_write_b32 v10, v12 offset:4252
    v_mov_b32 v14, 141424
    s_mov_b32 s85, 2097152
L_mws0:
    ds_read_b32 v15, v14
    s_sub_u32 s85, s85, 1
    s_cbranch_scc1 L_end
    s_waitcnt lgkmcnt(0)
    v_readfirstlane_b32 s60, v15
    s_and_b32 s61, s60, 0xff
    s_cmp_ge_u32 s61, 4
    s_cbranch_scc0 L_mws0
    s_add_u32 m0, s91, 4256
    s_add_u32 s60, s89, 4
    buffer_load_dwordx4 v1, s[32:35], s60 offen offset:0  lds
    buffer_load_dwordx4 v1, s[32:35], s60 offen offset:1024  lds
    buffer_load_dwordx4 v1, s[32:35], s60 offen offset:2048  lds
    buffer_load_dwordx4 v1, s[32:35], s60 offen offset:3072  lds
    s_add_u32 m0, s98, 87200
    s_add_u32 s60, s99, 4
    buffer_load_dwordx4 v1, s[32:35], s60 offen  lds
    s_add_u32 m0, s98, 91424
    s_sub_u32 s60, s99, 2
    buffer_load_dwordx4 v1, s[32:35], s60 offen  lds
    s_add_u32 m0, s98, 95648
    s_add_u32 s60, s99, 2
    buffer_load_dwordx4 v1, s[32:35], s60 offen  lds
    s_waitcnt vmcnt(0)
    ds_write_b32 v10, v12 offset:32
    s_cmp_lg_u32 s7, 0
    s_cbranch_scc1 L_nf5
    ds_write_b32 v11, v13 offset:32
L_nf5:
    v_mov_b32 v14, 141408
    v_mov_b32 v15, 1
    s_mov_b64 exec, 1
    ds_add_u32 v14, v15
    s_mov_b64 exec, -1
    ds_read_b64_tr_b16 v[16:17], v2 offset:0
    ds_read_b64_tr_b16 v[18:19], v2 offset:16
    ds_read_b64_tr_b16 v[20:21], v2 offset:128
    ds_read_b64_tr_b16 v[22:23], v2 offset:144
    ds_read_b64_tr_b16 v[24:25], v2 offset:256
    ds_read_b64_tr_b16 v[26:27], v2 offset:272
    ds_read_b64_tr_b16 v[28:29], v2 offset:384
    ds_read_b64_tr_b16 v[30:31], v2 offset:400
    ds_read_b64_tr_b16 v[32:33], v2 offset:512
    ds_read_b64_tr_b16 v[34:35], v2 offset:528
    ds_read_b64_tr_b16 v[36:37], v2 offset:640
    ds_read_b64_tr_b16 v[38:39], v2 offset:656
    ds_read_b64_tr_b16 v[40:41], v2 offset:768
    ds_read_b64_tr_b16 v[42:43], v2 offset:784
    ds_read_b64_tr_b16 v[44:45], v2 offset:896
    ds_read_b64_tr_b16 v[46:47], v2 offset:912
    s_waitcnt lgkmcnt(8)
    ds_read_b64_tr_b16 v[48:49], v2 offset:1024
    ds_read_b64_tr_b16 v[50:51], v2 offset:1040
    ds_read_b64_tr_b16 v[52:53], v2 offset:1152
    ds_read_b64_tr_b16 v[54:55], v2 offset:1168
    ds_read_b64_tr_b16 v[56:57], v2 offset:1280
    ds_read_b64_tr_b16 v[58:59], v2 offset:1296
    ds_read_b64_tr_b16 v[60:61], v2 offset:1408
    ds_read_b64_tr_b16 v[62:63], v2 offset:1424
    s_waitcnt lgkmcnt(8)
    ds_read_b64_tr_b16 v[64:65], v2 offset:1536
    ds_read_b64_tr_b16 v[66:67], v2 offset:1552
    ds_read_b64_tr_b16 v[68:69], v2 offset:1664
    ds_read_b64_tr_b16 v[70:71], v2 offset:1680
    ds_read_b64_tr_b16 v[72:73], v2 offset:1792
    ds_read_b64_tr_b16 v[74:75], v2 offset:1808
    ds_read_b64_tr_b16 v[76:77], v2 offset:1920
    ds_read_b64_tr_b16 v[78:79], v2 offset:1936
    s_waitcnt lgkmcnt(8)
    ds_read_b64_tr_b16 v[80:81], v2 offset:2048
    ds_read_b64_tr_b16 v[82:83], v2 offset:2064
    ds_read_b64_tr_b16 v[84:85], v2 offset:2176
    ds_read_b64_tr_b16 v[86:87], v2 offset:2192
    ds_read_b64_tr_b16 v[88:89], v2 offset:2304
    ds_read_b64_tr_b16 v[90:91], v2 offset:2320
    ds_read_b64_tr_b16 v[92:93], v2 offset:2432
    ds_read_b64_tr_b16 v[94:95], v2 offset:2448
    s_waitcnt lgkmcnt(8)
    ds_read_b64_tr_b16 v[96:97], v2 offset:2560
    ds_read_b64_tr_b16 v[98:99], v2 offset:2576
    ds_read_b64_tr_b16 v[100:101], v2 offset:2688
    ds_read_b64_tr_b16 v[102:103], v2 offset:2704
    ds_read_b64_tr_b16 v[104:105], v2 offset:2816
    ds_read_b64_tr_b16 v[106:107], v2 offset:2832
    ds_read_b64_tr_b16 v[108:109], v2 offset:2944
    ds_read_b64_tr_b16 v[110:111], v2 offset:2960
    s_waitcnt lgkmcnt(8)
    ds_read_b64_tr_b16 v[112:113], v2 offset:3072
    ds_read_b64_tr_b16 v[114:115], v2 offset:3088
    ds_read_b64_tr_b16 v[116:117], v2 offset:3200
    ds_read_b64_tr_b16 v[118:119], v2 offset:3216
    ds_read_b64_tr_b16 v[120:121], v2 offset:3328
    ds_read_b64_tr_b16 v[122:123], v2 offset:3344
    ds_read_b64_tr_b16 v[124:125], v2 offset:3456
    ds_read_b64_tr_b16 v[126:127], v2 offset:3472
    s_waitcnt lgkmcnt(8)
    ds_read_b64_tr_b16 v[128:129], v2 offset:3584
    ds_read_b64_tr_b16 v[130:131], v2 offset:3600
    ds_read_b64_tr_b16 v[132:133], v2 offset:3712
    ds_read_b64_tr_b16 v[134:135], v2 offset:3728
    ds_read_b64_tr_b16 v[136:137], v2 offset:3840
    ds_read_b64_tr_b16 v[138:139], v2 offset:3856
    ds_read_b64_tr_b16 v[140:141], v2 offset:3968
    ds_read_b64_tr_b16 v[142:143], v2 offset:3984
    s_waitcnt lgkmcnt(8)
    s_lshl_b32 s97, s5, 2
    s_add_u32 s97, s97, s7
    s_lshl_b32 s97, s97, 2
    s_lshr_b32 s100, s5, 4
    s_lshl_b32 s100, s100, 1
    s_lshr_b32 s60, s7, 1
    s_add_u32 s100, s100, s60
    s_and_b32 s61, s7, 1
    s_mul_i32 s60, s61, 8448
    s_add_u32 s60, s60, 82944
    s_sub_u32 s60, s60, s91
    v_add_u32 v3, s60, v2
    s_lshl_b32 s60, s7, 10
    s_add_u32 s60, s60, 131072
    v_add_u32 v7, s60, v1
    v_xor_b32 v254, 1024, v7
    s_and_b32 s98, s5, 15
    s_add_u32 s98, s98, 16
    s_lshl_b32 s98, s98, 12
    s_lshl_b32 s60, s100, 9
    s_add_u32 s61, s60, 2048
    s_sub_u32 s60, 1536, s60
    s_bitcmp1_b32 s7, 0
    s_cselect_b32 s60, s60, s61
    s_cselect_b64 s[62:63], -1, 0
    s_add_u32 s98, s98, s60
    s_lshr_b32 s60, s7, 1
    s_lshl_b32 s60, s60, 2
    s_add_u32 s99, s60, 141416
    v_mov_b32 v1, 141404
    s_waitcnt lgkmcnt(0)
    v_mov_b32 v10, 141408
    s_mov_b32 s85, 2097152
L_mwh5:
    ds_read_b32 v11, v10
    s_sub_u32 s85, s85, 1
    s_cbranch_scc1 L_end
    s_waitcnt lgkmcnt(0)
    v_readfirstlane_b32 s60, v11
    s_and_b32 s61, s60, 0xff
    s_cmp_ge_u32 s61, 4
    s_cbranch_scc0 L_mwh5
    s_call_b64 s[0:1], T_mt_f
    s_cmp_eq_u32 s100, 1
    s_cbranch_scc1 L_mv1_f
    s_cmp_eq_u32 s100, 2
    s_cbranch_scc1 L_mv2_f
    s_cmp_eq_u32 s100, 3
    s_cbranch_scc1 L_mv3_f
    s_branch L_mv0_f
.p2align 12
L_mv0_f:
    v_mov_b32 v10, 141396
    s_mov_b32 s85, 2097152
L_mwx0:
    ds_read_b32 v11, v10
    s_sub_u32 s85, s85, 1
    s_cbranch_scc1 L_end
    s_waitcnt lgkmcnt(0)
    v_readfirstlane_b32 s60, v11
    s_and_b32 s61, s60, 0xff
    s_cmp_ge_u32 s61, 4
    s_cbranch_scc0 L_mwx0
    ds_read_b128 v[208:211], v246 offset:14336
    ds_read_b128 v[212:215], v247 offset:14336
    s_cmp_ge_u32 s60, 0x100
    s_cbranch_scc1 L_Mslow
    s_waitcnt lgkmcnt(1)
    v_mfma_f32_16x16x32_bf16 v[144:147], v[16:19], v[208:211], 0
    ds_read_b64_tr_b16 v[216:217], v3 offset:0
    v_mfma_f32_16x16x32_bf16 v[148:151], v[32:35], v[208:211], 0
    ds_read_b64_tr_b16 v[218:219], v3 offset:16
    v_mfma_f32_16x16x32_bf16 v[152:155], v[48:51], v[208:211], 0
    ds_read_b128 v[228:231], v242 offset:0
    v_mfma_f32_16x16x32_bf16 v[156:159], v[64:67], v[208:211], 0
    ds_read_b64_tr_b16 v[220:221], v3 offset:128
    v_mfma_f32_16x16x32_bf16 v[160:163], v[80:83], v[208:211], 0
    ds_read_b64_tr_b16 v[222:223], v3 offset:144
    v_mfma_f32_16x16x32_bf16 v[164:167], v[96:99], v[208:211], 0
    ds_read_b128 v[232:235], v243 offset:0
    v_mfma_f32_16x16x32_bf16 v[168:171], v[112:115], v[208:211], 0
    s_waitcnt lgkmcnt(3)
    ds_read_b64_tr_b16 v[224:225], v3 offset:256
    v_mfma_f32_16x16x32_bf16 v[12:15], v[216:219], v[228:231], 0
    ds_read_b64_tr_b16 v[226:227], v3 offset:272
    v_mfma_f32_16x16x32_bf16 v[172:175], v[128:131], v[208:211], 0
    ds_read_b128 v[236:239], v244 offset:0
    v_mfma_f32_16x16x32_bf16 v[176:179], v[16:19], v[212:215], 0
    ds_read_b128 v[208:211], v248 offset:14336
    v_mfma_f32_16x16x32_bf16 v[180:183], v[32:35], v[212:215], 0
    s_waitcnt lgkmcnt(4)
    ds_read_b64_tr_b16 v[216:217], v3 offset:384
    v_mfma_f32_16x16x32_bf16 v[12:15], v[220:223], v[232:235], v[12:15]
    ds_read_b64_tr_b16 v[218:219], v3 offset:400
    v_mfma_f32_16x16x32_bf16 v[184:187], v[48:51], v[212:215], 0
    ds_read_b128 v[228:231], v245 offset:0
    v_mfma_f32_16x16x32_bf16 v[188:191], v[64:67], v[212:215], 0
    ds_read_b64_tr_b16 v[220:221], v3 offset:512
    v_mfma_f32_16x16x32_bf16 v[192:195], v[80:83], v[212:215], 0
    ds_read_b64_tr_b16 v[222:223], v3 offset:528
    v_mfma_f32_16x16x32_bf16 v[196:199], v[96:99], v[212:215], 0
    s_waitcnt lgkmcnt(5)
    ds_read_b128 v[232:235], v242 offset:512
    v_mfma_f32_16x16x32_bf16 v[12:15], v[224:227], v[236:239], v[12:15]
    v_mfma_f32_16x16x32_bf16 v[200:203], v[112:115], v[212:215], 0
    ds_read_b64_tr_b16 v[224:225], v3 offset:640
    v_mfma_f32_16x16x32_bf16 v[204:207], v[128:131], v[212:215], 0
    ds_read_b128 v[212:215], v249 offset:14336
    v_mfma_f32_16x16x32_bf16 v[144:147], v[20:23], v[208:211], v[144:147]
    ds_read_b64_tr_b16 v[226:227], v3 offset:656
    v_mfma_f32_16x16x32_bf16 v[148:151], v[36:39], v[208:211], v[148:151]
    s_waitcnt lgkmcnt(4)
    ds_read_b128 v[236:239], v243 offset:512
    v_mfma_f32_16x16x32_bf16 v[12:15], v[216:219], v[228:231], v[12:15]
    ds_read_b64_tr_b16 v[216:217], v3 offset:768
    v_mfma_f32_16x16x32_bf16 v[152:155], v[52:55], v[208:211], v[152:155]
    ds_read_b64_tr_b16 v[218:219], v3 offset:784
    v_mfma_f32_16x16x32_bf16 v[156:159], v[68:71], v[208:211], v[156:159]
    ds_read_b128 v[228:231], v244 offset:512
    v_mfma_f32_16x16x32_bf16 v[160:163], v[84:87], v[208:211], v[160:163]
    v_mfma_f32_16x16x32_bf16 v[164:167], v[100:103], v[208:211], v[164:167]
    s_waitcnt lgkmcnt(4)
    v_mfma_f32_16x16x32_bf16 v[12:15], v[220:223], v[232:235], v[12:15]
    ds_read_b64_tr_b16 v[220:221], v3 offset:896
    v_mfma_f32_16x16x32_bf16 v[168:171], v[116:119], v[208:211], v[168:171]
    ds_read_b64_tr_b16 v[222:223], v3 offset:912
    v_mfma_f32_16x16x32_bf16 v[172:175], v[132:135], v[208:211], v[172:175]
    ds_read_b128 v[208:211], v250 offset:14336
    v_mfma_f32_16x16x32_bf16 v[176:179], v[20:23], v[212:215], v[176:179]
    ds_read_b128 v[232:235], v245 offset:512
    v_mfma_f32_16x16x32_bf16 v[180:183], v[36:39], v[212:215], v[180:183]
    s_waitcnt lgkmcnt(4)
    v_mfma_f32_16x16x32_bf16 v[12:15], v[224:227], v[236:239], v[12:15]
    ds_read_b64_tr_b16 v[224:225], v3 offset:1024
    v_mfma_f32_16x16x32_bf16 v[184:187], v[52:55], v[212:215], v[184:187]
    ds_read_b64_tr_b16 v[226:227], v3 offset:1040
    v_mfma_f32_16x16x32_bf16 v[188:191], v[68:71], v[212:215], v[188:191]
    ds_read_b128 v[236:239], v242 offset:1024
    v_mfma_f32_16x16x32_bf16 v[192:195], v[84:87], v[212:215], v[192:195]
    v_mfma_f32_16x16x32_bf16 v[12:15], v[216:219], v[228:231], v[12:15]
    v_mfma_f32_16x16x32_bf16 v[196:199], v[100:103], v[212:215], v[196:199]
    ds_read_b64_tr_b16 v[216:217], v3 offset:1152
    v_mfma_f32_16x16x32_bf16 v[200:203], v[116:119], v[212:215], v[200:203]
    ds_read_b64_tr_b16 v[218:219], v3 offset:1168
    v_mfma_f32_16x16x32_bf16 v[204:207], v[132:135], v[212:215], v[204:207]
    s_waitcnt lgkmcnt(3)
    ds_read_b128 v[212:215], v251 offset:14336
    v_mfma_f32_16x16x32_bf16 v[144:147], v[24:27], v[208:211], v[144:147]
    ds_read_b128 v[228:231], v243 offset:1024
    v_mfma_f32_16x16x32_bf16 v[12:15], v[220:223], v[232:235], v[12:15]
    v_mfma_f32_16x16x32_bf16 v[148:151], v[40:43], v[208:211], v[148:151]
    ds_read_b64_tr_b16 v[220:221], v3 offset:1280
    v_mfma_f32_16x16x32_bf16 v[152:155], v[56:59], v[208:211], v[152:155]
    ds_read_b64_tr_b16 v[222:223], v3 offset:1296
    v_mfma_f32_16x16x32_bf16 v[156:159], v[72:75], v[208:211], v[156:159]
    ds_read_b128 v[232:235], v244 offset:1024
    v_mfma_f32_16x16x32_bf16 v[160:163], v[88:91], v[208:211], v[160:163]
    s_waitcnt lgkmcnt(4)
    v_mfma_f32_16x16x32_bf16 v[12:15], v[224:227], v[236:239], v[12:15]
    v_mfma_f32_16x16x32_bf16 v[164:167], v[104:107], v[208:211], v[164:167]
    ds_read_b64_tr_b16 v[224:225], v3 offset:1408
    v_mfma_f32_16x16x32_bf16 v[168:171], v[120:123], v[208:211], v[168:171]
    ds_read_b64_tr_b16 v[226:227], v3 offset:1424
    v_mfma_f32_16x16x32_bf16 v[172:175], v[136:139], v[208:211], v[172:175]
    ds_read_b128 v[208:211], v252 offset:14336
    v_mfma_f32_16x16x32_bf16 v[176:179], v[24:27], v[212:215], v[176:179]
    s_waitcnt lgkmcnt(3)
    ds_read_b128 v[236:239], v245 offset:1024
    v_mfma_f32_16x16x32_bf16 v[12:15], v[216:219], v[228:231], v[12:15]
    ds_read_b64_tr_b16 v[216:217], v3 offset:1536
    v_mfma_f32_16x16x32_bf16 v[180:183], v[40:43], v[212:215], v[180:183]
    ds_read_b64_tr_b16 v[218:219], v3 offset:1552
    v_mfma_f32_16x16x32_bf16 v[184:187], v[56:59], v[212:215], v[184:187]
    ds_read_b128 v[228:231], v242 offset:1536
    v_mfma_f32_16x16x32_bf16 v[188:191], v[72:75], v[212:215], v[188:191]
    v_mfma_f32_16x16x32_bf16 v[192:195], v[88:91], v[212:215], v[192:195]
    v_mfma_f32_16x16x32_bf16 v[12:15], v[220:223], v[232:235], v[12:15]
    ds_read_b64_tr_b16 v[220:221], v3 offset:1664
    v_mfma_f32_16x16x32_bf16 v[196:199], v[104:107], v[212:215], v[196:199]
    ds_read_b64_tr_b16 v[222:223], v3 offset:1680
    v_mfma_f32_16x16x32_bf16 v[200:203], v[120:123], v[212:215], v[200:203]
    ds_read_b128 v[232:235], v243 offset:1536
    v_mfma_f32_16x16x32_bf16 v[204:207], v[136:139], v[212:215], v[204:207]
    s_waitcnt lgkmcnt(3)
    ds_read_b128 v[212:215], v253 offset:14336
    v_mfma_f32_16x16x32_bf16 v[144:147], v[28:31], v[208:211], v[144:147]
    v_mfma_f32_16x16x32_bf16 v[12:15], v[224:227], v[236:239], v[12:15]
    ds_read_b64_tr_b16 v[224:225], v3 offset:1792
    v_mfma_f32_16x16x32_bf16 v[148:151], v[44:47], v[208:211], v[148:151]
    ds_read_b64_tr_b16 v[226:227], v3 offset:1808
    v_mfma_f32_16x16x32_bf16 v[152:155], v[60:63], v[208:211], v[152:155]
    ds_read_b128 v[236:239], v244 offset:1536
    v_mfma_f32_16x16x32_bf16 v[156:159], v[76:79], v[208:211], v[156:159]
    v_mfma_f32_16x16x32_bf16 v[12:15], v[216:219], v[228:231], v[12:15]
    v_mfma_f32_16x16x32_bf16 v[160:163], v[92:95], v[208:211], v[160:163]
    ds_read_b64_tr_b16 v[216:217], v3 offset:1920
    v_mfma_f32_16x16x32_bf16 v[164:167], v[108:111], v[208:211], v[164:167]
    ds_read_b64_tr_b16 v[218:219], v3 offset:1936
    v_mfma_f32_16x16x32_bf16 v[168:171], v[124:127], v[208:211], v[168:171]
    ds_read_b128 v[228:231], v245 offset:1536
    v_mfma_f32_16x16x32_bf16 v[172:175], v[140:143], v[208:211], v[172:175]
    s_waitcnt lgkmcnt(3)
    ds_read_b128 v[208:211], v246 offset:12288
    v_mfma_f32_16x16x32_bf16 v[12:15], v[220:223], v[232:235], v[12:15]
    v_mfma_f32_16x16x32_bf16 v[176:179], v[28:31], v[212:215], v[176:179]
    ds_read_b64_tr_b16 v[220:221], v3 offset:2048
    v_mfma_f32_16x16x32_bf16 v[180:183], v[44:47], v[212:215], v[180:183]
    ds_read_b64_tr_b16 v[222:223], v3 offset:2064
    v_mfma_f32_16x16x32_bf16 v[184:187], v[60:63], v[212:215], v[184:187]
    ds_read_b128 v[232:235], v242 offset:2048
    v_mfma_f32_16x16x32_bf16 v[188:191], v[76:79], v[212:215], v[188:191]
    v_mfma_f32_16x16x32_bf16 v[12:15], v[224:227], v[236:239], v[12:15]
    v_mfma_f32_16x16x32_bf16 v[192:195], v[92:95], v[212:215], v[192:195]
    ds_read_b64_tr_b16 v[224:225], v3 offset:2176
    v_bfi_b32 v240, v5, 0, v179
    v_mfma_f32_16x16x32_bf16 v[196:199], v[108:111], v[212:215], v[196:199]
    ds_bpermute_b32 v240, v4, v240
    v_add_f32 v146, v146, v177
    v_mfma_f32_16x16x32_bf16 v[200:203], v[124:127], v[212:215], v[200:203]
    ds_read_b64_tr_b16 v[226:227], v3 offset:2192
    v_add_f32 v147, v147, v178
    v_mfma_f32_16x16x32_bf16 v[204:207], v[140:143], v[212:215], v[204:207]
    s_waitcnt lgkmcnt(3)
    ds_read_b128 v[212:215], v247 offset:12288
    v_add_f32 v145, v145, v176
    v_mfma_f32_16x16x32_bf16 v[12:15], v[216:219], v[228:231], v[12:15]
    ds_read_b128 v[236:239], v243 offset:2048
    v_cvt_pk_bf16_f32 v9, v146, v147
    v_mfma_f32_16x16x32_bf16 v[148:151], v[16:19], v[208:211], v[148:151]
    ds_read_b64_tr_b16 v[216:217], v3 offset:2304
    v_mfma_f32_16x16x32_bf16 v[152:155], v[32:35], v[208:211], v[152:155]
    s_waitcnt lgkmcnt(4)
    ds_read_b64_tr_b16 v[218:219], v3 offset:2320
    v_add_f32 v144, v144, v240
    v_mfma_f32_16x16x32_bf16 v[156:159], v[48:51], v[208:211], v[156:159]
    ds_read_b128 v[228:231], v244 offset:2048
    v_cvt_pk_bf16_f32 v8, v144, v145
    v_mfma_f32_16x16x32_bf16 v[160:163], v[64:67], v[208:211], v[160:163]
    v_mfma_f32_16x16x32_bf16 v[12:15], v[220:223], v[232:235], v[12:15]
    ds_read_b64_tr_b16 v[220:221], v3 offset:2432
    v_mfma_f32_16x16x32_bf16 v[164:167], v[80:83], v[208:211], v[164:167]
    ds_read_b64_tr_b16 v[222:223], v3 offset:2448
    v_mfma_f32_16x16x32_bf16 v[168:171], v[96:99], v[208:211], v[168:171]
    ds_read_b128 v[232:235], v245 offset:2048
    v_mfma_f32_16x16x32_bf16 v[172:175], v[112:115], v[208:211], v[172:175]
    s_waitcnt lgkmcnt(4)
    ds_read_b128 v[208:211], v248 offset:12288
    v_mfma_f32_16x16x32_bf16 v[180:183], v[16:19], v[212:215], v[180:183]
    v_mfma_f32_16x16x32_bf16 v[12:15], v[224:227], v[236:239], v[12:15]
    ds_read_b64_tr_b16 v[224:225], v3 offset:2560
    v_mfma_f32_16x16x32_bf16 v[184:187], v[32:35], v[212:215], v[184:187]
    ds_read_b64_tr_b16 v[226:227], v3 offset:2576
    v_mfma_f32_16x16x32_bf16 v[188:191], v[48:51], v[212:215], v[188:191]
    ds_read_b128 v[236:239], v242 offset:2560
    v_mfma_f32_16x16x32_bf16 v[192:195], v[64:67], v[212:215], v[192:195]
    s_waitcnt lgkmcnt(4)
    v_mfma_f32_16x16x32_bf16 v[12:15], v[216:219], v[228:231], v[12:15]
    v_mfma_f32_16x16x32_bf16 v[196:199], v[80:83], v[212:215], v[196:199]
    ds_read_b64_tr_b16 v[216:217], v3 offset:2688
    v_mfma_f32_16x16x32_bf16 v[200:203], v[96:99], v[212:215], v[200:203]
    ds_read_b64_tr_b16 v[218:219], v3 offset:2704
    v_mfma_f32_16x16x32_bf16 v[204:207], v[112:115], v[212:215], v[204:207]
    s_waitcnt lgkmcnt(3)
    ds_read_b128 v[212:215], v249 offset:12288
    v_mfma_f32_16x16x32_bf16 v[148:151], v[20:23], v[208:211], v[148:151]
    ds_read_b128 v[228:231], v243 offset:2560
    v_mfma_f32_16x16x32_bf16 v[12:15], v[220:223], v[232:235], v[12:15]
    v_mfma_f32_16x16x32_bf16 v[152:155], v[36:39], v[208:211], v[152:155]
    ds_read_b64_tr_b16 v[220:221], v3 offset:2816
    v_mfma_f32_16x16x32_bf16 v[156:159], v[52:55], v[208:211], v[156:159]
    ds_read_b64_tr_b16 v[222:223], v3 offset:2832
    v_mfma_f32_16x16x32_bf16 v[160:163], v[68:71], v[208:211], v[160:163]
    ds_read_b128 v[232:235], v244 offset:2560
    v_mfma_f32_16x16x32_bf16 v[164:167], v[84:87], v[208:211], v[164:167]
    s_waitcnt lgkmcnt(4)
    v_mfma_f32_16x16x32_bf16 v[12:15], v[224:227], v[236:239], v[12:15]
    v_mfma_f32_16x16x32_bf16 v[168:171], v[100:103], v[208:211], v[168:171]
    ds_read_b64_tr_b16 v[224:225], v3 offset:2944
    v_mfma_f32_16x16x32_bf16 v[172:175], v[116:119], v[208:211], v[172:175]
    ds_read_b128 v[208:211], v250 offset:12288
    v_mfma_f32_16x16x32_bf16 v[180:183], v[20:23], v[212:215], v[180:183]
    ds_read_b64_tr_b16 v[226:227], v3 offset:2960
    v_mfma_f32_16x16x32_bf16 v[184:187], v[36:39], v[212:215], v[184:187]
    s_waitcnt lgkmcnt(3)
    ds_read_b128 v[236:239], v245 offset:2560
    v_mfma_f32_16x16x32_bf16 v[12:15], v[216:219], v[228:231], v[12:15]
    ds_read_b64_tr_b16 v[216:217], v3 offset:3072
    v_mfma_f32_16x16x32_bf16 v[188:191], v[52:55], v[212:215], v[188:191]
    ds_read_b64_tr_b16 v[218:219], v3 offset:3088
    v_mfma_f32_16x16x32_bf16 v[192:195], v[68:71], v[212:215], v[192:195]
    ds_read_b128 v[228:231], v242 offset:3072
    v_mfma_f32_16x16x32_bf16 v[196:199], v[84:87], v[212:215], v[196:199]
    v_mfma_f32_16x16x32_bf16 v[200:203], v[100:103], v[212:215], v[200:203]
    v_mfma_f32_16x16x32_bf16 v[12:15], v[220:223], v[232:235], v[12:15]
    ds_read_b64_tr_b16 v[220:221], v3 offset:3200
    v_mfma_f32_16x16x32_bf16 v[204:207], v[116:119], v[212:215], v[204:207]
    s_waitcnt lgkmcnt(3)
    ds_read_b128 v[212:215], v251 offset:12288
    v_mfma_f32_16x16x32_bf16 v[148:151], v[24:27], v[208:211], v[148:151]
    ds_read_b64_tr_b16 v[222:223], v3 offset:3216
    v_mfma_f32_16x16x32_bf16 v[152:155], v[40:43], v[208:211], v[152:155]
    ds_read_b128 v[232:235], v243 offset:3072
    v_mfma_f32_16x16x32_bf16 v[156:159], v[56:59], v[208:211], v[156:159]
    v_mfma_f32_16x16x32_bf16 v[12:15], v[224:227], v[236:239], v[12:15]
    ds_read_b64_tr_b16 v[224:225], v3 offset:3328
    v_mfma_f32_16x16x32_bf16 v[160:163], v[72:75], v[208:211], v[160:163]
    ds_read_b64_tr_b16 v[226:227], v3 offset:3344
    v_mfma_f32_16x16x32_bf16 v[164:167], v[88:91], v[208:211], v[164:167]
    ds_read_b128 v[236:239], v244 offset:3072
    v_mfma_f32_16x16x32_bf16 v[168:171], v[104:107], v[208:211], v[168:171]
    s_waitcnt lgkmcnt(4)
    v_mfma_f32_16x16x32_bf16 v[12:15], v[216:219], v[228:231], v[12:15]
    v_mfma_f32_16x16x32_bf16 v[172:175], v[120:123], v[208:211], v[172:175]
    ds_read_b128 v[208:211], v252 offset:12288
    v_mfma_f32_16x16x32_bf16 v[180:183], v[24:27], v[212:215], v[180:183]
    ds_read_b64_tr_b16 v[216:217], v3 offset:3456
    v_mfma_f32_16x16x32_bf16 v[184:187], v[40:43], v[212:215], v[184:187]
    ds_read_b64_tr_b16 v[218:219], v3 offset:3472
    v_mfma_f32_16x16x32_bf16 v[188:191], v[56:59], v[212:215], v[188:191]
    s_waitcnt lgkmcnt(3)
    ds_read_b128 v[228:231], v245 offset:3072
    v_mfma_f32_16x16x32_bf16 v[12:15], v[220:223], v[232:235], v[12:15]
    v_mfma_f32_16x16x32_bf16 v[192:195], v[72:75], v[212:215], v[192:195]
    ds_read_b64_tr_b16 v[220:221], v3 offset:3584
    v_mfma_f32_16x16x32_bf16 v[196:199], v[88:91], v[212:215], v[196:199]
    ds_read_b64_tr_b16 v[222:223], v3 offset:3600
    v_mfma_f32_16x16x32_bf16 v[200:203], v[104:107], v[212:215], v[200:203]
    ds_read_b128 v[232:235], v242 offset:3584
    v_mfma_f32_16x16x32_bf16 v[204:207], v[120:123], v[212:215], v[204:207]
    ds_read_b128 v[212:215], v253 offset:12288
    v_mfma_f32_16x16x32_bf16 v[12:15], v[224:227], v[236:239], v[12:15]
    s_waitcnt lgkmcnt(4)
    v_mfma_f32_16x16x32_bf16 v[148:151], v[28:31], v[208:211], v[148:151]
    ds_read_b64_tr_b16 v[224:225], v3 offset:3712
    v_mfma_f32_16x16x32_bf16 v[152:155], v[44:47], v[208:211], v[152:155]
    ds_read_b64_tr_b16 v[226:227], v3 offset:3728
    v_mfma_f32_16x16x32_bf16 v[156:159], v[60:63], v[208:211], v[156:159]
    ds_read_b128 v[236:239], v243 offset:3584
    v_mfma_f32_16x16x32_bf16 v[160:163], v[76:79], v[208:211], v[160:163]
    v_mfma_f32_16x16x32_bf16 v[12:15], v[216:219], v[228:231], v[12:15]
    ds_read_b64_tr_b16 v[216:217], v3 offset:3840
    v_mfma_f32_16x16x32_bf16 v[164:167], v[92:95], v[208:211], v[164:167]
    ds_read_b64_tr_b16 v[218:219], v3 offset:3856
    v_mfma_f32_16x16x32_bf16 v[168:171], v[108:111], v[208:211], v[168:171]
    ds_read_b128 v[228:231], v244 offset:3584
    v_mfma_f32_16x16x32_bf16 v[172:175], v[124:127], v[208:211], v[172:175]
    s_waitcnt lgkmcnt(4)
    ds_read_b128 v[208:211], v246 offset:10240
    v_mfma_f32_16x16x32_bf16 v[180:183], v[28:31], v[212:215], v[180:183]
    v_mfma_f32_16x16x32_bf16 v[12:15], v[220:223], v[232:235], v[12:15]
    ds_read_b64_tr_b16 v[220:221], v3 offset:3968
    v_mfma_f32_16x16x32_bf16 v[184:187], v[44:47], v[212:215], v[184:187]
    ds_read_b64_tr_b16 v[222:223], v3 offset:3984
    v_mfma_f32_16x16x32_bf16 v[188:191], v[60:63], v[212:215], v[188:191]
    ds_read_b128 v[232:235], v245 offset:3584
    v_mfma_f32_16x16x32_bf16 v[192:195], v[76:79], v[212:215], v[192:195]
    v_mfma_f32_16x16x32_bf16 v[196:199], v[92:95], v[212:215], v[196:199]
    s_waitcnt lgkmcnt(3)
    v_bfi_b32 v241, v5, v179, v183
    v_add_f32 v150, v150, v181
    v_mfma_f32_16x16x32_bf16 v[12:15], v[224:227], v[236:239], v[12:15]
    ds_bpermute_b32 v241, v4, v241
    v_add_f32 v151, v151, v182
    v_mfma_f32_16x16x32_bf16 v[200:203], v[108:111], v[212:215], v[200:203]
    ds_read_b64_tr_b16 v[224:225], v3 offset:0
    v_add_f32 v149, v149, v180
    v_mfma_f32_16x16x32_bf16 v[204:207], v[124:127], v[212:215], v[204:207]
    ds_read_b128 v[212:215], v247 offset:10240
    v_cvt_pk_bf16_f32 v11, v150, v151
    v_mfma_f32_16x16x32_bf16 v[152:155], v[16:19], v[208:211], v[152:155]
    ds_read_b64_tr_b16 v[226:227], v3 offset:16
    v_mfma_f32_16x16x32_bf16 v[12:15], v[216:219], v[228:231], v[12:15]
    ds_read_b128 v[236:239], v242 offset:3584
    v_mfma_f32_16x16x32_bf16 v[156:159], v[32:35], v[208:211], v[156:159]
    s_waitcnt lgkmcnt(4)
    ds_read_b64_tr_b16 v[216:217], v3 offset:128
    v_add_f32 v148, v148, v241
    v_mfma_f32_16x16x32_bf16 v[160:163], v[48:51], v[208:211], v[160:163]
    ds_read_b64_tr_b16 v[218:219], v3 offset:144
    v_cvt_pk_bf16_f32 v10, v148, v149
    v_mfma_f32_16x16x32_bf16 v[164:167], v[64:67], v[208:211], v[164:167]
    ds_read_b128 v[228:231], v243 offset:3584
    v_permlane16_swap_b32 v9, v11
    v_mfma_f32_16x16x32_bf16 v[168:171], v[80:83], v[208:211], v[168:171]
    v_mfma_f32_16x16x32_bf16 v[12:15], v[220:223], v[232:235], v[12:15]
    v_permlane16_swap_b32 v8, v10
    v_mfma_f32_16x16x32_bf16 v[172:175], v[96:99], v[208:211], v[172:175]
    s_waitcnt lgkmcnt(3)
    buffer_store_dwordx4 v[8:11], v6, s[36:39], s52 offen
    v_mfma_f32_16x16x32_bf16 v[184:187], v[16:19], v[212:215], v[184:187]
    ds_read_b128 v[208:211], v248 offset:10240
    v_mfma_f32_16x16x32_bf16 v[188:191], v[32:35], v[212:215], v[188:191]
    ds_read_b64_tr_b16 v[220:221], v3 offset:256
    v_mfma_f32_16x16x32_bf16 v[192:195], v[48:51], v[212:215], v[192:195]
    ds_read_b64_tr_b16 v[222:223], v3 offset:272
    v_mfma_f32_16x16x32_bf16 v[140:143], v[224:227], v[236:239], 0
    ds_read_b128 v[232:235], v244 offset:3584
    v_mfma_f32_16x16x32_bf16 v[196:199], v[64:67], v[212:215], v[196:199]
    ds_read_b64_tr_b16 v[224:225], v3 offset:384
    v_mfma_f32_16x16x32_bf16 v[200:203], v[80:83], v[212:215], v[200:203]
    ds_read_b64_tr_b16 v[226:227], v3 offset:400
    s_branch L_mt_f
.p2align 12
L_mv1_f:
    v_mov_b32 v10, 141396
    s_mov_b32 s85, 2097152
L_mwx01:
    ds_read_b32 v11, v10
    s_sub_u32 s85, s85, 1
    s_cbranch_scc1 L_end
    s_waitcnt lgkmcnt(0)
    v_readfirstlane_b32 s60, v11
    s_and_b32 s61, s60, 0xff
    s_cmp_ge_u32 s61, 4
    s_cbranch_scc0 L_mwx01
    ds_read_b128 v[208:211], v246 offset:14336
    ds_read_b128 v[212:215], v247 offset:14336
    s_cmp_ge_u32 s60, 0x100
    s_cbranch_scc1 L_Mslow
    s_waitcnt lgkmcnt(1)
    v_mfma_f32_16x16x32_bf16 v[144:147], v[16:19], v[208:211], 0
    ds_read_b64_tr_b16 v[216:217], v3 offset:0
    v_mfma_f32_16x16x32_bf16 v[148:151], v[32:35], v[208:211], 0
    ds_read_b64_tr_b16 v[218:219], v3 offset:16
    v_mfma_f32_16x16x32_bf16 v[152:155], v[48:51], v[208:211], 0
    ds_read_b128 v[228:231], v242 offset:512
    v_mfma_f32_16x16x32_bf16 v[156:159], v[64:67], v[208:211], 0
    ds_read_b64_tr_b16 v[220:221], v3 offset:128
    v_mfma_f32_16x16x32_bf16 v[160:163], v[80:83], v[208:211], 0
    ds_read_b64_tr_b16 v[222:223], v3 offset:144
    v_mfma_f32_16x16x32_bf16 v[164:167], v[96:99], v[208:211], 0
    ds_read_b128 v[232:235], v243 offset:512
    v_mfma_f32_16x16x32_bf16 v[168:171], v[112:115], v[208:211], 0
    s_waitcnt lgkmcnt(3)
    ds_read_b64_tr_b16 v[224:225], v3 offset:256
    v_mfma_f32_16x16x32_bf16 v[12:15], v[216:219], v[228:231], 0
    ds_read_b64_tr_b16 v[226:227], v3 offset:272
    v_mfma_f32_16x16x32_bf16 v[172:175], v[128:131], v[208:211], 0
    ds_read_b128 v[236:239], v244 offset:512
    v_mfma_f32_16x16x32_bf16 v[176:179], v[16:19], v[212:215], 0
    ds_read_b128 v[208:211], v248 offset:14336
    v_mfma_f32_16x16x32_bf16 v[180:183], v[32:35], v[212:215], 0
    s_waitcnt lgkmcnt(4)
    ds_read_b64_tr_b16 v[216:217], v3 offset:384
    v_mfma_f32_16x16x32_bf16 v[12:15], v[220:223], v[232:235], v[12:15]
    ds_read_b64_tr_b16 v[218:219], v3 offset:400
    v_mfma_f32_16x16x32_bf16 v[184:187], v[48:51], v[212:215], 0
    ds_read_b128 v[228:231], v245 offset:512
    v_mfma_f32_16x16x32_bf16 v[188:191], v[64:67], v[212:215], 0
    ds_read_b64_tr_b16 v[220:221], v3 offset:512
    v_mfma_f32_16x16x32_bf16 v[192:195], v[80:83], v[212:215], 0
    ds_read_b64_tr_b16 v[222:223], v3 offset:528
    v_mfma_f32_16x16x32_bf16 v[196:199], v[96:99], v[212:215], 0
    s_waitcnt lgkmcnt(5)
    ds_read_b128 v[232:235], v242 offset:1024
    v_mfma_f32_16x16x32_bf16 v[12:15], v[224:227], v[236:239], v[12:15]
    v_mfma_f32_16x16x32_bf16 v[200:203], v[112:115], v[212:215], 0
    ds_read_b64_tr_b16 v[224:225], v3 offset:640
    v_mfma_f32_16x16x32_bf16 v[204:207], v[128:131], v[212:215], 0
    ds_read_b128 v[212:215], v249 offset:14336
    v_mfma_f32_16x16x32_bf16 v[144:147], v[20:23], v[208:211], v[144:147]
    ds_read_b64_tr_b16 v[226:227], v3 offset:656
    v_mfma_f32_16x16x32_bf16 v[148:151], v[36:39], v[208:211], v[148:151]
    s_waitcnt lgkmcnt(4)
    ds_read_b128 v[236:239], v243 offset:1024
    v_mfma_f32_16x16x32_bf16 v[12:15], v[216:219], v[228:231], v[12:15]
    ds_read_b64_tr_b16 v[216:217], v3 offset:768
    v_mfma_f32_16x16x32_bf16 v[152:155], v[52:55], v[208:211], v[152:155]
    ds_read_b64_tr_b16 v[218:219], v3 offset:784
    v_mfma_f32_16x16x32_bf16 v[156:159], v[68:71], v[208:211], v[156:159]
    ds_read_b128 v[228:231], v244 offset:1024
    v_mfma_f32_16x16x32_bf16 v[160:163], v[84:87], v[208:211], v[160:163]
    v_mfma_f32_16x16x32_bf16 v[164:167], v[100:103], v[208:211], v[164:167]
    s_waitcnt lgkmcnt(4)
    v_mfma_f32_16x16x32_bf16 v[12:15], v[220:223], v[232:235], v[12:15]
    ds_read_b64_tr_b16 v[220:221], v3 offset:896
    v_mfma_f32_16x16x32_bf16 v[168:171], v[116:119], v[208:211], v[168:171]
    ds_read_b64_tr_b16 v[222:223], v3 offset:912
    v_mfma_f32_16x16x32_bf16 v[172:175], v[132:135], v[208:211], v[172:175]
    ds_read_b128 v[208:211], v250 offset:14336
    v_mfma_f32_16x16x32_bf16 v[176:179], v[20:23], v[212:215], v[176:179]
    ds_read_b128 v[232:235], v245 offset:1024
    v_mfma_f32_16x16x32_bf16 v[180:183], v[36:39], v[212:215], v[180:183]
    s_waitcnt lgkmcnt(4)
    v_mfma_f32_16x16x32_bf16 v[12:15], v[224:227], v[236:239], v[12:15]
    ds_read_b64_tr_b16 v[224:225], v3 offset:1024
    v_mfma_f32_16x16x32_bf16 v[184:187], v[52:55], v[212:215], v[184:187]
    ds_read_b64_tr_b16 v[226:227], v3 offset:1040
    v_mfma_f32_16x16x32_bf16 v[188:191], v[68:71], v[212:215], v[188:191]
    ds_read_b128 v[236:239], v242 offset:1536
    v_mfma_f32_16x16x32_bf16 v[192:195], v[84:87], v[212:215], v[192:195]
    v_mfma_f32_16x16x32_bf16 v[12:15], v[216:219], v[228:231], v[12:15]
    v_mfma_f32_16x16x32_bf16 v[196:199], v[100:103], v[212:215], v[196:199]
    ds_read_b64_tr_b16 v[216:217], v3 offset:1152
    v_mfma_f32_16x16x32_bf16 v[200:203], v[116:119], v[212:215], v[200:203]
    ds_read_b64_tr_b16 v[218:219], v3 offset:1168
    v_mfma_f32_16x16x32_bf16 v[204:207], v[132:135], v[212:215], v[204:207]
    s_waitcnt lgkmcnt(3)
    ds_read_b128 v[212:215], v251 offset:14336
    v_mfma_f32_16x16x32_bf16 v[144:147], v[24:27], v[208:211], v[144:147]
    ds_read_b128 v[228:231], v243 offset:1536
    v_mfma_f32_16x16x32_bf16 v[12:15], v[220:223], v[232:235], v[12:15]
    v_mfma_f32_16x16x32_bf16 v[148:151], v[40:43], v[208:211], v[148:151]
    ds_read_b64_tr_b16 v[220:221], v3 offset:1280
    v_mfma_f32_16x16x32_bf16 v[152:155], v[56:59], v[208:211], v[152:155]
    ds_read_b64_tr_b16 v[222:223], v3 offset:1296
    v_mfma_f32_16x16x32_bf16 v[156:159], v[72:75], v[208:211], v[156:159]
    ds_read_b128 v[232:235], v244 offset:1536
    v_mfma_f32_16x16x32_bf16 v[160:163], v[88:91], v[208:211], v[160:163]
    s_waitcnt lgkmcnt(4)
    v_mfma_f32_16x16x32_bf16 v[12:15], v[224:227], v[236:239], v[12:15]
    v_mfma_f32_16x16x32_bf16 v[164:167], v[104:107], v[208:211], v[164:167]
    ds_read_b64_tr_b16 v[224:225], v3 offset:1408
    v_mfma_f32_16x16x32_bf16 v[168:171], v[120:123], v[208:211], v[168:171]
    ds_read_b64_tr_b16 v[226:227], v3 offset:1424
    v_mfma_f32_16x16x32_bf16 v[172:175], v[136:139], v[208:211], v[172:175]
    ds_read_b128 v[208:211], v252 offset:14336
    v_mfma_f32_16x16x32_bf16 v[176:179], v[24:27], v[212:215], v[176:179]
    s_waitcnt lgkmcnt(3)
    ds_read_b128 v[236:239], v245 offset:1536
    v_mfma_f32_16x16x32_bf16 v[12:15], v[216:219], v[228:231], v[12:15]
    ds_read_b64_tr_b16 v[216:217], v3 offset:1536
    v_mfma_f32_16x16x32_bf16 v[180:183], v[40:43], v[212:215], v[180:183]
    ds_read_b64_tr_b16 v[218:219], v3 offset:1552
    v_mfma_f32_16x16x32_bf16 v[184:187], v[56:59], v[212:215], v[184:187]
    ds_read_b128 v[228:231], v242 offset:2048
    v_mfma_f32_16x16x32_bf16 v[188:191], v[72:75], v[212:215], v[188:191]
    v_mfma_f32_16x16x32_bf16 v[192:195], v[88:91], v[212:215], v[192:195]
    v_mfma_f32_16x16x32_bf16 v[12:15], v[220:223], v[232:235], v[12:15]
    ds_read_b64_tr_b16 v[220:221], v3 offset:1664
    v_mfma_f32_16x16x32_bf16 v[196:199], v[104:107], v[212:215], v[196:199]
    ds_read_b64_tr_b16 v[222:223], v3 offset:1680
    v_mfma_f32_16x16x32_bf16 v[200:203], v[120:123], v[212:215], v[200:203]
    ds_read_b128 v[232:235], v243 offset:2048
    v_mfma_f32_16x16x32_bf16 v[204:207], v[136:139], v[212:215], v[204:207]
    s_waitcnt lgkmcnt(3)
    ds_read_b128 v[212:215], v253 offset:14336
    v_mfma_f32_16x16x32_bf16 v[144:147], v[28:31], v[208:211], v[144:147]
    v_mfma_f32_16x16x32_bf16 v[12:15], v[224:227], v[236:239], v[12:15]
    ds_read_b64_tr_b16 v[224:225], v3 offset:1792
    v_mfma_f32_16x16x32_bf16 v[148:151], v[44:47], v[208:211], v[148:151]
    ds_read_b64_tr_b16 v[226:227], v3 offset:1808
    v_mfma_f32_16x16x32_bf16 v[152:155], v[60:63], v[208:211], v[152:155]
    ds_read_b128 v[236:239], v244 offset:2048
    v_mfma_f32_16x16x32_bf16 v[156:159], v[76:79], v[208:211], v[156:159]
    v_mfma_f32_16x16x32_bf16 v[12:15], v[216:219], v[228:231], v[12:15]
    v_mfma_f32_16x16x32_bf16 v[160:163], v[92:95], v[208:211], v[160:163]
    ds_read_b64_tr_b16 v[216:217], v3 offset:1920
    v_mfma_f32_16x16x32_bf16 v[164:167], v[108:111], v[208:211], v[164:167]
    ds_read_b64_tr_b16 v[218:219], v3 offset:1936
    v_mfma_f32_16x16x32_bf16 v[168:171], v[124:127], v[208:211], v[168:171]
    ds_read_b128 v[228:231], v245 offset:2048
    v_mfma_f32_16x16x32_bf16 v[172:175], v[140:143], v[208:211], v[172:175]
    s_waitcnt lgkmcnt(3)
    ds_read_b128 v[208:211], v246 offset:12288
    v_mfma_f32_16x16x32_bf16 v[12:15], v[220:223], v[232:235], v[12:15]
    v_mfma_f32_16x16x32_bf16 v[176:179], v[28:31], v[212:215], v[176:179]
    ds_read_b64_tr_b16 v[220:221], v3 offset:2048
    v_mfma_f32_16x16x32_bf16 v[180:183], v[44:47], v[212:215], v[180:183]
    ds_read_b64_tr_b16 v[222:223], v3 offset:2064
    v_mfma_f32_16x16x32_bf16 v[184:187], v[60:63], v[212:215], v[184:187]
    ds_read_b128 v[232:235], v242 offset:2560
    v_mfma_f32_16x16x32_bf16 v[188:191], v[76:79], v[212:215], v[188:191]
    v_mfma_f32_16x16x32_bf16 v[12:15], v[224:227], v[236:239], v[12:15]
    v_mfma_f32_16x16x32_bf16 v[192:195], v[92:95], v[212:215], v[192:195]
    ds_read_b64_tr_b16 v[224:225], v3 offset:2176
    v_bfi_b32 v240, v5, 0, v179
    v_mfma_f32_16x16x32_bf16 v[196:199], v[108:111], v[212:215], v[196:199]
    ds_bpermute_b32 v240, v4, v240
    v_add_f32 v146, v146, v177
    v_mfma_f32_16x16x32_bf16 v[200:203], v[124:127], v[212:215], v[200:203]
    ds_read_b64_tr_b16 v[226:227], v3 offset:2192
    v_add_f32 v147, v147, v178
    v_mfma_f32_16x16x32_bf16 v[204:207], v[140:143], v[212:215], v[204:207]
    s_waitcnt lgkmcnt(3)
    ds_read_b128 v[212:215], v247 offset:12288
    v_add_f32 v145, v145, v176
    v_mfma_f32_16x16x32_bf16 v[12:15], v[216:219], v[228:231], v[12:15]
    ds_read_b128 v[236:239], v243 offset:2560
    v_cvt_pk_bf16_f32 v9, v146, v147
    v_mfma_f32_16x16x32_bf16 v[148:151], v[16:19], v[208:211], v[148:151]
    ds_read_b64_tr_b16 v[216:217], v3 offset:2304
    v_mfma_f32_16x16x32_bf16 v[152:155], v[32:35], v[208:211], v[152:155]
    s_waitcnt lgkmcnt(4)
    ds_read_b64_tr_b16 v[218:219], v3 offset:2320
    v_add_f32 v144, v144, v240
    v_mfma_f32_16x16x32_bf16 v[156:159], v[48:51], v[208:211], v[156:159]
    ds_read_b128 v[228:231], v244 offset:2560
    v_cvt_pk_bf16_f32 v8, v144, v145
    v_mfma_f32_16x16x32_bf16 v[160:163], v[64:67], v[208:211], v[160:163]
    v_mfma_f32_16x16x32_bf16 v[12:15], v[220:223], v[232:235], v[12:15]
    ds_read_b64_tr_b16 v[220:221], v3 offset:2432
    v_mfma_f32_16x16x32_bf16 v[164:167], v[80:83], v[208:211], v[164:167]
    ds_read_b64_tr_b16 v[222:223], v3 offset:2448
    v_mfma_f32_16x16x32_bf16 v[168:171], v[96:99], v[208:211], v[168:171]
    ds_read_b128 v[232:235], v245 offset:2560
    v_mfma_f32_16x16x32_bf16 v[172:175], v[112:115], v[208:211], v[172:175]
    s_waitcnt lgkmcnt(4)
    ds_read_b128 v[208:211], v248 offset:12288
    v_mfma_f32_16x16x32_bf16 v[180:183], v[16:19], v[212:215], v[180:183]
    v_mfma_f32_16x16x32_bf16 v[12:15], v[224:227], v[236:239], v[12:15]
    ds_read_b64_tr_b16 v[224:225], v3 offset:2560
    v_mfma_f32_16x16x32_bf16 v[184:187], v[32:35], v[212:215], v[184:187]
    ds_read_b64_tr_b16 v[226:227], v3 offset:2576
    v_mfma_f32_16x16x32_bf16 v[188:191], v[48:51], v[212:215], v[188:191]
    ds_read_b128 v[236:239], v242 offset:3072
    v_mfma_f32_16x16x32_bf16 v[192:195], v[64:67], v[212:215], v[192:195]
    s_waitcnt lgkmcnt(4)
    v_mfma_f32_16x16x32_bf16 v[12:15], v[216:219], v[228:231], v[12:15]
    v_mfma_f32_16x16x32_bf16 v[196:199], v[80:83], v[212:215], v[196:199]
    ds_read_b64_tr_b16 v[216:217], v3 offset:2688
    v_mfma_f32_16x16x32_bf16 v[200:203], v[96:99], v[212:215], v[200:203]
    ds_read_b64_tr_b16 v[218:219], v3 offset:2704
    v_mfma_f32_16x16x32_bf16 v[204:207], v[112:115], v[212:215], v[204:207]
    s_waitcnt lgkmcnt(3)
    ds_read_b128 v[212:215], v249 offset:12288
    v_mfma_f32_16x16x32_bf16 v[148:151], v[20:23], v[208:211], v[148:151]
    ds_read_b128 v[228:231], v243 offset:3072
    v_mfma_f32_16x16x32_bf16 v[12:15], v[220:223], v[232:235], v[12:15]
    v_mfma_f32_16x16x32_bf16 v[152:155], v[36:39], v[208:211], v[152:155]
    ds_read_b64_tr_b16 v[220:221], v3 offset:2816
    v_mfma_f32_16x16x32_bf16 v[156:159], v[52:55], v[208:211], v[156:159]
    ds_read_b64_tr_b16 v[222:223], v3 offset:2832
    v_mfma_f32_16x16x32_bf16 v[160:163], v[68:71], v[208:211], v[160:163]
    ds_read_b128 v[232:235], v244 offset:3072
    v_mfma_f32_16x16x32_bf16 v[164:167], v[84:87], v[208:211], v[164:167]
    s_waitcnt lgkmcnt(4)
    v_mfma_f32_16x16x32_bf16 v[12:15], v[224:227], v[236:239], v[12:15]
    v_mfma_f32_16x16x32_bf16 v[168:171], v[100:103], v[208:211], v[168:171]
    ds_read_b64_tr_b16 v[224:225], v3 offset:2944
    v_mfma_f32_16x16x32_bf16 v[172:175], v[116:119], v[208:211], v[172:175]
    ds_read_b128 v[208:211], v250 offset:12288
    v_mfma_f32_16x16x32_bf16 v[180:183], v[20:23], v[212:215], v[180:183]
    ds_read_b64_tr_b16 v[226:227], v3 offset:2960
    v_mfma_f32_16x16x32_bf16 v[184:187], v[36:39], v[212:215], v[184:187]
    s_waitcnt lgkmcnt(3)
    ds_read_b128 v[236:239], v245 offset:3072
    v_mfma_f32_16x16x32_bf16 v[12:15], v[216:219], v[228:231], v[12:15]
    ds_read_b64_tr_b16 v[216:217], v3 offset:3072
    v_mfma_f32_16x16x32_bf16 v[188:191], v[52:55], v[212:215], v[188:191]
    ds_read_b64_tr_b16 v[218:219], v3 offset:3088
    v_mfma_f32_16x16x32_bf16 v[192:195], v[68:71], v[212:215], v[192:195]
    ds_read_b128 v[228:231], v242 offset:3584
    v_mfma_f32_16x16x32_bf16 v[196:199], v[84:87], v[212:215], v[196:199]
    v_mfma_f32_16x16x32_bf16 v[200:203], v[100:103], v[212:215], v[200:203]
    v_mfma_f32_16x16x32_bf16 v[12:15], v[220:223], v[232:235], v[12:15]
    ds_read_b64_tr_b16 v[220:221], v3 offset:3200
    v_mfma_f32_16x16x32_bf16 v[204:207], v[116:119], v[212:215], v[204:207]
    s_waitcnt lgkmcnt(3)
    ds_read_b128 v[212:215], v251 offset:12288
    v_mfma_f32_16x16x32_bf16 v[148:151], v[24:27], v[208:211], v[148:151]
    ds_read_b64_tr_b16 v[222:223], v3 offset:3216
    v_mfma_f32_16x16x32_bf16 v[152:155], v[40:43], v[208:211], v[152:155]
    ds_read_b128 v[232:235], v243 offset:3584
    v_mfma_f32_16x16x32_bf16 v[156:159], v[56:59], v[208:211], v[156:159]
    v_mfma_f32_16x16x32_bf16 v[12:15], v[224:227], v[236:239], v[12:15]
    ds_read_b64_tr_b16 v[224:225], v3 offset:3328
    v_mfma_f32_16x16x32_bf16 v[160:163], v[72:75], v[208:211], v[160:163]
    ds_read_b64_tr_b16 v[226:227], v3 offset:3344
    v_mfma_f32_16x16x32_bf16 v[164:167], v[88:91], v[208:211], v[164:167]
    ds_read_b128 v[236:239], v244 offset:3584
    v_mfma_f32_16x16x32_bf16 v[168:171], v[104:107], v[208:211], v[168:171]
    s_waitcnt lgkmcnt(4)
    v_mfma_f32_16x16x32_bf16 v[12:15], v[216:219], v[228:231], v[12:15]
    v_mfma_f32_16x16x32_bf16 v[172:175], v[120:123], v[208:211], v[172:175]
    ds_read_b128 v[208:211], v252 offset:12288
    v_mfma_f32_16x16x32_bf16 v[180:183], v[24:27], v[212:215], v[180:183]
    ds_read_b64_tr_b16 v[216:217], v3 offset:3456
    v_mfma_f32_16x16x32_bf16 v[184:187], v[40:43], v[212:215], v[184:187]
    ds_read_b64_tr_b16 v[218:219], v3 offset:3472
    v_mfma_f32_16x16x32_bf16 v[188:191], v[56:59], v[212:215], v[188:191]
    s_waitcnt lgkmcnt(3)
    ds_read_b128 v[228:231], v245 offset:3584
    v_mfma_f32_16x16x32_bf16 v[12:15], v[220:223], v[232:235], v[12:15]
    v_mfma_f32_16x16x32_bf16 v[192:195], v[72:75], v[212:215], v[192:195]
    ds_read_b64_tr_b16 v[220:221], v3 offset:0
    v_mfma_f32_16x16x32_bf16 v[196:199], v[88:91], v[212:215], v[196:199]
    ds_read_b64_tr_b16 v[222:223], v3 offset:16
    v_mfma_f32_16x16x32_bf16 v[200:203], v[104:107], v[212:215], v[200:203]
    ds_read_b128 v[232:235], v242 offset:3072
    v_mfma_f32_16x16x32_bf16 v[204:207], v[120:123], v[212:215], v[204:207]
    ds_read_b128 v[212:215], v253 offset:12288
    v_mfma_f32_16x16x32_bf16 v[12:15], v[224:227], v[236:239], v[12:15]
    s_waitcnt lgkmcnt(4)
    v_mfma_f32_16x16x32_bf16 v[148:151], v[28:31], v[208:211], v[148:151]
    ds_read_b64_tr_b16 v[224:225], v3 offset:128
    v_mfma_f32_16x16x32_bf16 v[152:155], v[44:47], v[208:211], v[152:155]
    ds_read_b64_tr_b16 v[226:227], v3 offset:144
    v_mfma_f32_16x16x32_bf16 v[156:159], v[60:63], v[208:211], v[156:159]
    ds_read_b128 v[236:239], v243 offset:3072
    v_mfma_f32_16x16x32_bf16 v[160:163], v[76:79], v[208:211], v[160:163]
    v_mfma_f32_16x16x32_bf16 v[12:15], v[216:219], v[228:231], v[12:15]
    ds_read_b64_tr_b16 v[216:217], v3 offset:256
    v_mfma_f32_16x16x32_bf16 v[164:167], v[92:95], v[208:211], v[164:167]
    ds_read_b64_tr_b16 v[218:219], v3 offset:272
    v_mfma_f32_16x16x32_bf16 v[168:171], v[108:111], v[208:211], v[168:171]
    ds_read_b128 v[228:231], v244 offset:3072
    v_mfma_f32_16x16x32_bf16 v[172:175], v[124:127], v[208:211], v[172:175]
    s_waitcnt lgkmcnt(4)
    ds_read_b128 v[208:211], v246 offset:10240
    v_mfma_f32_16x16x32_bf16 v[180:183], v[28:31], v[212:215], v[180:183]
    v_mfma_f32_16x16x32_bf16 v[140:143], v[220:223], v[232:235], 0
    ds_read_b64_tr_b16 v[220:221], v3 offset:384
    v_mfma_f32_16x16x32_bf16 v[184:187], v[44:47], v[212:215], v[184:187]
    ds_read_b64_tr_b16 v[222:223], v3 offset:400
    v_mfma_f32_16x16x32_bf16 v[188:191], v[60:63], v[212:215], v[188:191]
    ds_read_b128 v[232:235], v245 offset:3072
    v_mfma_f32_16x16x32_bf16 v[192:195], v[76:79], v[212:215], v[192:195]
    v_mfma_f32_16x16x32_bf16 v[196:199], v[92:95], v[212:215], v[196:199]
    s_waitcnt lgkmcnt(3)
    v_bfi_b32 v241, v5, v179, v183
    v_add_f32 v150, v150, v181
    v_mfma_f32_16x16x32_bf16 v[140:143], v[224:227], v[236:239], v[140:143]
    ds_bpermute_b32 v241, v4, v241
    v_add_f32 v151, v151, v182
    v_mfma_f32_16x16x32_bf16 v[200:203], v[108:111], v[212:215], v[200:203]
    ds_read_b64_tr_b16 v[224:225], v3 offset:512
    v_add_f32 v149, v149, v180
    v_mfma_f32_16x16x32_bf16 v[204:207], v[124:127], v[212:215], v[204:207]
    ds_read_b128 v[212:215], v247 offset:10240
    v_cvt_pk_bf16_f32 v11, v150, v151
    v_mfma_f32_16x16x32_bf16 v[152:155], v[16:19], v[208:211], v[152:155]
    ds_read_b64_tr_b16 v[226:227], v3 offset:528
    v_mfma_f32_16x16x32_bf16 v[140:143], v[216:219], v[228:231], v[140:143]
    ds_read_b128 v[236:239], v242 offset:3584
    v_mfma_f32_16x16x32_bf16 v[156:159], v[32:35], v[208:211], v[156:159]
    s_waitcnt lgkmcnt(4)
    ds_read_b64_tr_b16 v[216:217], v3 offset:640
    v_add_f32 v148, v148, v241
    v_mfma_f32_16x16x32_bf16 v[160:163], v[48:51], v[208:211], v[160:163]
    ds_read_b64_tr_b16 v[218:219], v3 offset:656
    v_cvt_pk_bf16_f32 v10, v148, v149
    v_mfma_f32_16x16x32_bf16 v[164:167], v[64:67], v[208:211], v[164:167]
    ds_read_b128 v[228:231], v243 offset:3584
    v_permlane16_swap_b32 v9, v11
    v_mfma_f32_16x16x32_bf16 v[168:171], v[80:83], v[208:211], v[168:171]
    v_mfma_f32_16x16x32_bf16 v[140:143], v[220:223], v[232:235], v[140:143]
    v_permlane16_swap_b32 v8, v10
    v_mfma_f32_16x16x32_bf16 v[172:175], v[96:99], v[208:211], v[172:175]
    s_waitcnt lgkmcnt(3)
    buffer_store_dwordx4 v[8:11], v6, s[36:39], s52 offen
    v_mfma_f32_16x16x32_bf16 v[184:187], v[16:19], v[212:215], v[184:187]
    ds_read_b128 v[208:211], v248 offset:10240
    v_mfma_f32_16x16x32_bf16 v[188:191], v[32:35], v[212:215], v[188:191]
    ds_read_b64_tr_b16 v[220:221], v3 offset:768
    v_mfma_f32_16x16x32_bf16 v[192:195], v[48:51], v[212:215], v[192:195]
    ds_read_b64_tr_b16 v[222:223], v3 offset:784
    v_mfma_f32_16x16x32_bf16 v[140:143], v[224:227], v[236:239], v[140:143]
    ds_read_b128 v[232:235], v244 offset:3584
    v_mfma_f32_16x16x32_bf16 v[196:199], v[64:67], v[212:215], v[196:199]
    ds_read_b64_tr_b16 v[224:225], v3 offset:896
    v_mfma_f32_16x16x32_bf16 v[200:203], v[80:83], v[212:215], v[200:203]
    ds_read_b64_tr_b16 v[226:227], v3 offset:912
    s_branch L_mt_f
.p2align 12
L_mv2_f:
    v_mov_b32 v10, 141396
    s_mov_b32 s85, 2097152
L_mwx02:
    ds_read_b32 v11, v10
    s_sub_u32 s85, s85, 1
    s_cbranch_scc1 L_end
    s_waitcnt lgkmcnt(0)
    v_readfirstlane_b32 s60, v11
    s_and_b32 s61, s60, 0xff
    s_cmp_ge_u32 s61, 4
    s_cbranch_scc0 L_mwx02
    ds_read_b128 v[208:211], v246 offset:14336
    ds_read_b128 v[212:215], v247 offset:14336
    s_cmp_ge_u32 s60, 0x100
    s_cbranch_scc1 L_Mslow
    s_waitcnt lgkmcnt(1)
    v_mfma_f32_16x16x32_bf16 v[144:147], v[16:19], v[208:211], 0
    ds_read_b64_tr_b16 v[216:217], v3 offset:0
    v_mfma_f32_16x16x32_bf16 v[148:151], v[32:35], v[208:211], 0
    ds_read_b64_tr_b16 v[218:219], v3 offset:16
    v_mfma_f32_16x16x32_bf16 v[152:155], v[48:51], v[208:211], 0
    ds_read_b128 v[228:231], v242 offset:1024
    v_mfma_f32_16x16x32_bf16 v[156:159], v[64:67], v[208:211], 0
    ds_read_b64_tr_b16 v[220:221], v3 offset:128
    v_mfma_f32_16x16x32_bf16 v[160:163], v[80:83], v[208:211], 0
    ds_read_b64_tr_b16 v[222:223], v3 offset:144
    v_mfma_f32_16x16x32_bf16 v[164:167], v[96:99], v[208:211], 0
    ds_read_b128 v[232:235], v243 offset:1024
    v_mfma_f32_16x16x32_bf16 v[168:171], v[112:115], v[208:211], 0
    s_waitcnt lgkmcnt(3)
    ds_read_b64_tr_b16 v[224:225], v3 offset:256
    v_mfma_f32_16x16x32_bf16 v[12:15], v[216:219], v[228:231], 0
    ds_read_b64_tr_b16 v[226:227], v3 offset:272
    v_mfma_f32_16x16x32_bf16 v[172:175], v[128:131], v[208:211], 0
    ds_read_b128 v[236:239], v244 offset:1024
    v_mfma_f32_16x16x32_bf16 v[176:179], v[16:19], v[212:215], 0
    ds_read_b128 v[208:211], v248 offset:14336
    v_mfma_f32_16x16x32_bf16 v[180:183], v[32:35], v[212:215], 0
    s_waitcnt lgkmcnt(4)
    ds_read_b64_tr_b16 v[216:217], v3 offset:384
    v_mfma_f32_16x16x32_bf16 v[12:15], v[220:223], v[232:235], v[12:15]
    ds_read_b64_tr_b16 v[218:219], v3 offset:400
    v_mfma_f32_16x16x32_bf16 v[184:187], v[48:51], v[212:215], 0
    ds_read_b128 v[228:231], v245 offset:1024
    v_mfma_f32_16x16x32_bf16 v[188:191], v[64:67], v[212:215], 0
    ds_read_b64_tr_b16 v[220:221], v3 offset:512
    v_mfma_f32_16x16x32_bf16 v[192:195], v[80:83], v[212:215], 0
    ds_read_b64_tr_b16 v[222:223], v3 offset:528
    v_mfma_f32_16x16x32_bf16 v[196:199], v[96:99], v[212:215], 0
    s_waitcnt lgkmcnt(5)
    ds_read_b128 v[232:235], v242 offset:1536
    v_mfma_f32_16x16x32_bf16 v[12:15], v[224:227], v[236:239], v[12:15]
    v_mfma_f32_16x16x32_bf16 v[200:203], v[112:115], v[212:215], 0
    ds_read_b64_tr_b16 v[224:225], v3 offset:640
    v_mfma_f32_16x16x32_bf16 v[204:207], v[128:131], v[212:215], 0
    ds_read_b128 v[212:215], v249 offset:14336
    v_mfma_f32_16x16x32_bf16 v[144:147], v[20:23], v[208:211], v[144:147]
    ds_read_b64_tr_b16 v[226:227], v3 offset:656
    v_mfma_f32_16x16x32_bf16 v[148:151], v[36:39], v[208:211], v[148:151]
    s_waitcnt lgkmcnt(4)
    ds_read_b128 v[236:239], v243 offset:1536
    v_mfma_f32_16x16x32_bf16 v[12:15], v[216:219], v[228:231], v[12:15]
    ds_read_b64_tr_b16 v[216:217], v3 offset:768
    v_mfma_f32_16x16x32_bf16 v[152:155], v[52:55], v[208:211], v[152:155]
    ds_read_b64_tr_b16 v[218:219], v3 offset:784
    v_mfma_f32_16x16x32_bf16 v[156:159], v[68:71], v[208:211], v[156:159]
    ds_read_b128 v[228:231], v244 offset:1536
    v_mfma_f32_16x16x32_bf16 v[160:163], v[84:87], v[208:211], v[160:163]
    v_mfma_f32_16x16x32_bf16 v[164:167], v[100:103], v[208:211], v[164:167]
    s_waitcnt lgkmcnt(4)
    v_mfma_f32_16x16x32_bf16 v[12:15], v[220:223], v[232:235], v[12:15]
    ds_read_b64_tr_b16 v[220:221], v3 offset:896
    v_mfma_f32_16x16x32_bf16 v[168:171], v[116:119], v[208:211], v[168:171]
    ds_read_b64_tr_b16 v[222:223], v3 offset:912
    v_mfma_f32_16x16x32_bf16 v[172:175], v[132:135], v[208:211], v[172:175]
    ds_read_b128 v[208:211], v250 offset:14336
    v_mfma_f32_16x16x32_bf16 v[176:179], v[20:23], v[212:215], v[176:179]
    ds_read_b128 v[232:235], v245 offset:1536
    v_mfma_f32_16x16x32_bf16 v[180:183], v[36:39], v[212:215], v[180:183]
    s_waitcnt lgkmcnt(4)
    v_mfma_f32_16x16x32_bf16 v[12:15], v[224:227], v[236:239], v[12:15]
    ds_read_b64_tr_b16 v[224:225], v3 offset:1024
    v_mfma_f32_16x16x32_bf16 v[184:187], v[52:55], v[212:215], v[184:187]
    ds_read_b64_tr_b16 v[226:227], v3 offset:1040
    v_mfma_f32_16x16x32_bf16 v[188:191], v[68:71], v[212:215], v[188:191]
    ds_read_b128 v[236:239], v242 offset:2048
    v_mfma_f32_16x16x32_bf16 v[192:195], v[84:87], v[212:215], v[192:195]
    v_mfma_f32_16x16x32_bf16 v[12:15], v[216:219], v[228:231], v[12:15]
    v_mfma_f32_16x16x32_bf16 v[196:199], v[100:103], v[212:215], v[196:199]
    ds_read_b64_tr_b16 v[216:217], v3 offset:1152
    v_mfma_f32_16x16x32_bf16 v[200:203], v[116:119], v[212:215], v[200:203]
    ds_read_b64_tr_b16 v[218:219], v3 offset:1168
    v_mfma_f32_16x16x32_bf16 v[204:207], v[132:135], v[212:215], v[204:207]
    s_waitcnt lgkmcnt(3)
    ds_read_b128 v[212:215], v251 offset:14336
    v_mfma_f32_16x16x32_bf16 v[144:147], v[24:27], v[208:211], v[144:147]
    ds_read_b128 v[228:231], v243 offset:2048
    v_mfma_f32_16x16x32_bf16 v[12:15], v[220:223], v[232:235], v[12:15]
    v_mfma_f32_16x16x32_bf16 v[148:151], v[40:43], v[208:211], v[148:151]
    ds_read_b64_tr_b16 v[220:221], v3 offset:1280
    v_mfma_f32_16x16x32_bf16 v[152:155], v[56:59], v[208:211], v[152:155]
    ds_read_b64_tr_b16 v[222:223], v3 offset:1296
    v_mfma_f32_16x16x32_bf16 v[156:159], v[72:75], v[208:211], v[156:159]
    ds_read_b128 v[232:235], v244 offset:2048
    v_mfma_f32_16x16x32_bf16 v[160:163], v[88:91], v[208:211], v[160:163]
    s_waitcnt lgkmcnt(4)
    v_mfma_f32_16x16x32_bf16 v[12:15], v[224:227], v[236:239], v[12:15]
    v_mfma_f32_16x16x32_bf16 v[164:167], v[104:107], v[208:211], v[164:167]
    ds_read_b64_tr_b16 v[224:225], v3 offset:1408
    v_mfma_f32_16x16x32_bf16 v[168:171], v[120:123], v[208:211], v[168:171]
    ds_read_b64_tr_b16 v[226:227], v3 offset:1424
    v_mfma_f32_16x16x32_bf16 v[172:175], v[136:139], v[208:211], v[172:175]
    ds_read_b128 v[208:211], v252 offset:14336
    v_mfma_f32_16x16x32_bf16 v[176:179], v[24:27], v[212:215], v[176:179]
    s_waitcnt lgkmcnt(3)
    ds_read_b128 v[236:239], v245 offset:2048
    v_mfma_f32_16x16x32_bf16 v[12:15], v[216:219], v[228:231], v[12:15]
    ds_read_b64_tr_b16 v[216:217], v3 offset:1536
    v_mfma_f32_16x16x32_bf16 v[180:183], v[40:43], v[212:215], v[180:183]
    ds_read_b64_tr_b16 v[218:219], v3 offset:1552
    v_mfma_f32_16x16x32_bf16 v[184:187], v[56:59], v[212:215], v[184:187]
    ds_read_b128 v[228:231], v242 offset:2560
    v_mfma_f32_16x16x32_bf16 v[188:191], v[72:75], v[212:215], v[188:191]
    v_mfma_f32_16x16x32_bf16 v[192:195], v[88:91], v[212:215], v[192:195]
    v_mfma_f32_16x16x32_bf16 v[12:15], v[220:223], v[232:235], v[12:15]
    ds_read_b64_tr_b16 v[220:221], v3 offset:1664
    v_mfma_f32_16x16x32_bf16 v[196:199], v[104:107], v[212:215], v[196:199]
    ds_read_b64_tr_b16 v[222:223], v3 offset:1680
    v_mfma_f32_16x16x32_bf16 v[200:203], v[120:123], v[212:215], v[200:203]
    ds_read_b128 v[232:235], v243 offset:2560
    v_mfma_f32_16x16x32_bf16 v[204:207], v[136:139], v[212:215], v[204:207]
    s_waitcnt lgkmcnt(3)
    ds_read_b128 v[212:215], v253 offset:14336
    v_mfma_f32_16x16x32_bf16 v[144:147], v[28:31], v[208:211], v[144:147]
    v_mfma_f32_16x16x32_bf16 v[12:15], v[224:227], v[236:239], v[12:15]
    ds_read_b64_tr_b16 v[224:225], v3 offset:1792
    v_mfma_f32_16x16x32_bf16 v[148:151], v[44:47], v[208:211], v[148:151]
    ds_read_b64_tr_b16 v[226:227], v3 offset:1808
    v_mfma_f32_16x16x32_bf16 v[152:155], v[60:63], v[208:211], v[152:155]
    ds_read_b128 v[236:239], v244 offset:2560
    v_mfma_f32_16x16x32_bf16 v[156:159], v[76:79], v[208:211], v[156:159]
    v_mfma_f32_16x16x32_bf16 v[12:15], v[216:219], v[228:231], v[12:15]
    v_mfma_f32_16x16x32_bf16 v[160:163], v[92:95], v[208:211], v[160:163]
    ds_read_b64_tr_b16 v[216:217], v3 offset:1920
    v_mfma_f32_16x16x32_bf16 v[164:167], v[108:111], v[208:211], v[164:167]
    ds_read_b64_tr_b16 v[218:219], v3 offset:1936
    v_mfma_f32_16x16x32_bf16 v[168:171], v[124:127], v[208:211], v[168:171]
    ds_read_b128 v[228:231], v245 offset:2560
    v_mfma_f32_16x16x32_bf16 v[172:175], v[140:143], v[208:211], v[172:175]
    s_waitcnt lgkmcnt(3)
    ds_read_b128 v[208:211], v246 offset:12288
    v_mfma_f32_16x16x32_bf16 v[12:15], v[220:223], v[232:235], v[12:15]
    v_mfma_f32_16x16x32_bf16 v[176:179], v[28:31], v[212:215], v[176:179]
    ds_read_b64_tr_b16 v[220:221], v3 offset:2048
    v_mfma_f32_16x16x32_bf16 v[180:183], v[44:47], v[212:215], v[180:183]
    ds_read_b64_tr_b16 v[222:223], v3 offset:2064
    v_mfma_f32_16x16x32_bf16 v[184:187], v[60:63], v[212:215], v[184:187]
    ds_read_b128 v[232:235], v242 offset:3072
    v_mfma_f32_16x16x32_bf16 v[188:191], v[76:79], v[212:215], v[188:191]
    v_mfma_f32_16x16x32_bf16 v[12:15], v[224:227], v[236:239], v[12:15]
    v_mfma_f32_16x16x32_bf16 v[192:195], v[92:95], v[212:215], v[192:195]
    ds_read_b64_tr_b16 v[224:225], v3 offset:2176
    v_bfi_b32 v240, v5, 0, v179
    v_mfma_f32_16x16x32_bf16 v[196:199], v[108:111], v[212:215], v[196:199]
    ds_bpermute_b32 v240, v4, v240
    v_add_f32 v146, v146, v177
    v_mfma_f32_16x16x32_bf16 v[200:203], v[124:127], v[212:215], v[200:203]
    ds_read_b64_tr_b16 v[226:227], v3 offset:2192
    v_add_f32 v147, v147, v178
    v_mfma_f32_16x16x32_bf16 v[204:207], v[140:143], v[212:215], v[204:207]
    s_waitcnt lgkmcnt(3)
    ds_read_b128 v[212:215], v247 offset:12288
    v_add_f32 v145, v145, v176
    v_mfma_f32_16x16x32_bf16 v[12:15], v[216:219], v[228:231], v[12:15]
    ds_read_b128 v[236:239], v243 offset:3072
    v_cvt_pk_bf16_f32 v9, v146, v147
    v_mfma_f32_16x16x32_bf16 v[148:151], v[16:19], v[208:211], v[148:151]
    ds_read_b64_tr_b16 v[216:217], v3 offset:2304
    v_mfma_f32_16x16x32_bf16 v[152:155], v[32:35], v[208:211], v[152:155]
    s_waitcnt lgkmcnt(4)
    ds_read_b64_tr_b16 v[218:219], v3 offset:2320
    v_add_f32 v144, v144, v240
    v_mfma_f32_16x16x32_bf16 v[156:159], v[48:51], v[208:211], v[156:159]
    ds_read_b128 v[228:231], v244 offset:3072
    v_cvt_pk_bf16_f32 v8, v144, v145
    v_mfma_f32_16x16x32_bf16 v[160:163], v[64:67], v[208:211], v[160:163]
    v_mfma_f32_16x16x32_bf16 v[12:15], v[220:223], v[232:235], v[12:15]
    ds_read_b64_tr_b16 v[220:221], v3 offset:2432
    v_mfma_f32_16x16x32_bf16 v[164:167], v[80:83], v[208:211], v[164:167]
    ds_read_b64_tr_b16 v[222:223], v3 offset:2448
    v_mfma_f32_16x16x32_bf16 v[168:171], v[96:99], v[208:211], v[168:171]
    ds_read_b128 v[232:235], v245 offset:3072
    v_mfma_f32_16x16x32_bf16 v[172:175], v[112:115], v[208:211], v[172:175]
    s_waitcnt lgkmcnt(4)
    ds_read_b128 v[208:211], v248 offset:12288
    v_mfma_f32_16x16x32_bf16 v[180:183], v[16:19], v[212:215], v[180:183]
    v_mfma_f32_16x16x32_bf16 v[12:15], v[224:227], v[236:239], v[12:15]
    ds_read_b64_tr_b16 v[224:225], v3 offset:2560
    v_mfma_f32_16x16x32_bf16 v[184:187], v[32:35], v[212:215], v[184:187]
    ds_read_b64_tr_b16 v[226:227], v3 offset:2576
    v_mfma_f32_16x16x32_bf16 v[188:191], v[48:51], v[212:215], v[188:191]
    ds_read_b128 v[236:239], v242 offset:3584
    v_mfma_f32_16x16x32_bf16 v[192:195], v[64:67], v[212:215], v[192:195]
    s_waitcnt lgkmcnt(4)
    v_mfma_f32_16x16x32_bf16 v[12:15], v[216:219], v[228:231], v[12:15]
    v_mfma_f32_16x16x32_bf16 v[196:199], v[80:83], v[212:215], v[196:199]
    ds_read_b64_tr_b16 v[216:217], v3 offset:2688
    v_mfma_f32_16x16x32_bf16 v[200:203], v[96:99], v[212:215], v[200:203]
    ds_read_b64_tr_b16 v[218:219], v3 offset:2704
    v_mfma_f32_16x16x32_bf16 v[204:207], v[112:115], v[212:215], v[204:207]
    s_waitcnt lgkmcnt(3)
    ds_read_b128 v[212:215], v249 offset:12288
    v_mfma_f32_16x16x32_bf16 v[148:151], v[20:23], v[208:211], v[148:151]
    ds_read_b128 v[228:231], v243 offset:3584
    v_mfma_f32_16x16x32_bf16 v[12:15], v[220:223], v[232:235], v[12:15]
    v_mfma_f32_16x16x32_bf16 v[152:155], v[36:39], v[208:211], v[152:155]
    ds_read_b64_tr_b16 v[220:221], v3 offset:2816
    v_mfma_f32_16x16x32_bf16 v[156:159], v[52:55], v[208:211], v[156:159]
    ds_read_b64_tr_b16 v[222:223], v3 offset:2832
    v_mfma_f32_16x16x32_bf16 v[160:163], v[68:71], v[208:211], v[160:163]
    ds_read_b128 v[232:235], v244 offset:3584
    v_mfma_f32_16x16x32_bf16 v[164:167], v[84:87], v[208:211], v[164:167]
    s_waitcnt lgkmcnt(4)
    v_mfma_f32_16x16x32_bf16 v[12:15], v[224:227], v[236:239], v[12:15]
    v_mfma_f32_16x16x32_bf16 v[168:171], v[100:103], v[208:211], v[168:171]
    ds_read_b64_tr_b16 v[224:225], v3 offset:2944
    v_mfma_f32_16x16x32_bf16 v[172:175], v[116:119], v[208:211], v[172:175]
    ds_read_b128 v[208:211], v250 offset:12288
    v_mfma_f32_16x16x32_bf16 v[180:183], v[20:23], v[212:215], v[180:183]
    ds_read_b64_tr_b16 v[226:227], v3 offset:2960
    v_mfma_f32_16x16x32_bf16 v[184:187], v[36:39], v[212:215], v[184:187]
    s_waitcnt lgkmcnt(3)
    ds_read_b128 v[236:239], v245 offset:3584
    v_mfma_f32_16x16x32_bf16 v[12:15], v[216:219], v[228:231], v[12:15]
    ds_read_b64_tr_b16 v[216:217], v3 offset:0
    v_mfma_f32_16x16x32_bf16 v[188:191], v[52:55], v[212:215], v[188:191]
    ds_read_b64_tr_b16 v[218:219], v3 offset:16
    v_mfma_f32_16x16x32_bf16 v[192:195], v[68:71], v[212:215], v[192:195]
    ds_read_b128 v[228:231], v242 offset:2560
    v_mfma_f32_16x16x32_bf16 v[196:199], v[84:87], v[212:215], v[196:199]
    v_mfma_f32_16x16x32_bf16 v[200:203], v[100:103], v[212:215], v[200:203]
    v_mfma_f32_16x16x32_bf16 v[12:15], v[220:223], v[232:235], v[12:15]
    ds_read_b64_tr_b16 v[220:221], v3 offset:128
    v_mfma_f32_16x16x32_bf16 v[204:207], v[116:119], v[212:215], v[204:207]
    s_waitcnt lgkmcnt(3)
    ds_read_b128 v[212:215], v251 offset:12288
    v_mfma_f32_16x16x32_bf16 v[148:151], v[24:27], v[208:211], v[148:151]
    ds_read_b64_tr_b16 v[222:223], v3 offset:144
    v_mfma_f32_16x16x32_bf16 v[152:155], v[40:43], v[208:211], v[152:155]
    ds_read_b128 v[232:235], v243 offset:2560
    v_mfma_f32_16x16x32_bf16 v[156:159], v[56:59], v[208:211], v[156:159]
    v_mfma_f32_16x16x32_bf16 v[12:15], v[224:227], v[236:239], v[12:15]
    ds_read_b64_tr_b16 v[224:225], v3 offset:256
    v_mfma_f32_16x16x32_bf16 v[160:163], v[72:75], v[208:211], v[160:163]
    ds_read_b64_tr_b16 v[226:227], v3 offset:272
    v_mfma_f32_16x16x32_bf16 v[164:167], v[88:91], v[208:211], v[164:167]
    ds_read_b128 v[236:239], v244 offset:2560
    v_mfma_f32_16x16x32_bf16 v[168:171], v[104:107], v[208:211], v[168:171]
    s_waitcnt lgkmcnt(4)
    v_mfma_f32_16x16x32_bf16 v[140:143], v[216:219], v[228:231], 0
    v_mfma_f32_16x16x32_bf16 v[172:175], v[120:123], v[208:211], v[172:175]
    ds_read_b128 v[208:211], v252 offset:12288
    v_mfma_f32_16x16x32_bf16 v[180:183], v[24:27], v[212:215], v[180:183]
    ds_read_b64_tr_b16 v[216:217], v3 offset:384
    v_mfma_f32_16x16x32_bf16 v[184:187], v[40:43], v[212:215], v[184:187]
    ds_read_b64_tr_b16 v[218:219], v3 offset:400
    v_mfma_f32_16x16x32_bf16 v[188:191], v[56:59], v[212:215], v[188:191]
    s_waitcnt lgkmcnt(3)
    ds_read_b128 v[228:231], v245 offset:2560
    v_mfma_f32_16x16x32_bf16 v[140:143], v[220:223], v[232:235], v[140:143]
    v_mfma_f32_16x16x32_bf16 v[192:195], v[72:75], v[212:215], v[192:195]
    ds_read_b64_tr_b16 v[220:221], v3 offset:512
    v_mfma_f32_16x16x32_bf16 v[196:199], v[88:91], v[212:215], v[196:199]
    ds_read_b64_tr_b16 v[222:223], v3 offset:528
    v_mfma_f32_16x16x32_bf16 v[200:203], v[104:107], v[212:215], v[200:203]
    ds_read_b128 v[232:235], v242 offset:3072
    v_mfma_f32_16x16x32_bf16 v[204:207], v[120:123], v[212:215], v[204:207]
    ds_read_b128 v[212:215], v253 offset:12288
    v_mfma_f32_16x16x32_bf16 v[140:143], v[224:227], v[236:239], v[140:143]
    s_waitcnt lgkmcnt(4)
    v_mfma_f32_16x16x32_bf16 v[148:151], v[28:31], v[208:211], v[148:151]
    ds_read_b64_tr_b16 v[224:225], v3 offset:640
    v_mfma_f32_16x16x32_bf16 v[152:155], v[44:47], v[208:211], v[152:155]
    ds_read_b64_tr_b16 v[226:227], v3 offset:656
    v_mfma_f32_16x16x32_bf16 v[156:159], v[60:63], v[208:211], v[156:159]
    ds_read_b128 v[236:239], v243 offset:3072
    v_mfma_f32_16x16x32_bf16 v[160:163], v[76:79], v[208:211], v[160:163]
    v_mfma_f32_16x16x32_bf16 v[140:143], v[216:219], v[228:231], v[140:143]
    ds_read_b64_tr_b16 v[216:217], v3 offset:768
    v_mfma_f32_16x16x32_bf16 v[164:167], v[92:95], v[208:211], v[164:167]
    ds_read_b64_tr_b16 v[218:219], v3 offset:784
    v_mfma_f32_16x16x32_bf16 v[168:171], v[108:111], v[208:211], v[168:171]
    ds_read_b128 v[228:231], v244 offset:3072
    v_mfma_f32_16x16x32_bf16 v[172:175], v[124:127], v[208:211], v[172:175]
    s_waitcnt lgkmcnt(4)
    ds_read_b128 v[208:211], v246 offset:10240
    v_mfma_f32_16x16x32_bf16 v[180:183], v[28:31], v[212:215], v[180:183]
    v_mfma_f32_16x16x32_bf16 v[140:143], v[220:223], v[232:235], v[140:143]
    ds_read_b64_tr_b16 v[220:221], v3 offset:896
    v_mfma_f32_16x16x32_bf16 v[184:187], v[44:47], v[212:215], v[184:187]
    ds_read_b64_tr_b16 v[222:223], v3 offset:912
    v_mfma_f32_16x16x32_bf16 v[188:191], v[60:63], v[212:215], v[188:191]
    ds_read_b128 v[232:235], v245 offset:3072
    v_mfma_f32_16x16x32_bf16 v[192:195], v[76:79], v[212:215], v[192:195]
    v_mfma_f32_16x16x32_bf16 v[196:199], v[92:95], v[212:215], v[196:199]
    s_waitcnt lgkmcnt(3)
    v_bfi_b32 v241, v5, v179, v183
    v_add_f32 v150, v150, v181
    v_mfma_f32_16x16x32_bf16 v[140:143], v[224:227], v[236:239], v[140:143]
    ds_bpermute_b32 v241, v4, v241
    v_add_f32 v151, v151, v182
    v_mfma_f32_16x16x32_bf16 v[200:203], v[108:111], v[212:215], v[200:203]
    ds_read_b64_tr_b16 v[224:225], v3 offset:1024
    v_add_f32 v149, v149, v180
    v_mfma_f32_16x16x32_bf16 v[204:207], v[124:127], v[212:215], v[204:207]
    ds_read_b128 v[212:215], v247 offset:10240
    v_cvt_pk_bf16_f32 v11, v150, v151
    v_mfma_f32_16x16x32_bf16 v[152:155], v[16:19], v[208:211], v[152:155]
    ds_read_b64_tr_b16 v[226:227], v3 offset:1040
    v_mfma_f32_16x16x32_bf16 v[140:143], v[216:219], v[228:231], v[140:143]
    ds_read_b128 v[236:239], v242 offset:3584
    v_mfma_f32_16x16x32_bf16 v[156:159], v[32:35], v[208:211], v[156:159]
    s_waitcnt lgkmcnt(4)
    ds_read_b64_tr_b16 v[216:217], v3 offset:1152
    v_add_f32 v148, v148, v241
    v_mfma_f32_16x16x32_bf16 v[160:163], v[48:51], v[208:211], v[160:163]
    ds_read_b64_tr_b16 v[218:219], v3 offset:1168
    v_cvt_pk_bf16_f32 v10, v148, v149
    v_mfma_f32_16x16x32_bf16 v[164:167], v[64:67], v[208:211], v[164:167]
    ds_read_b128 v[228:231], v243 offset:3584
    v_permlane16_swap_b32 v9, v11
    v_mfma_f32_16x16x32_bf16 v[168:171], v[80:83], v[208:211], v[168:171]
    v_mfma_f32_16x16x32_bf16 v[140:143], v[220:223], v[232:235], v[140:143]
    v_permlane16_swap_b32 v8, v10
    v_mfma_f32_16x16x32_bf16 v[172:175], v[96:99], v[208:211], v[172:175]
    s_waitcnt lgkmcnt(3)
    buffer_store_dwordx4 v[8:11], v6, s[36:39], s52 offen
    v_mfma_f32_16x16x32_bf16 v[184:187], v[16:19], v[212:215], v[184:187]
    ds_read_b128 v[208:211], v248 offset:10240
    v_mfma_f32_16x16x32_bf16 v[188:191], v[32:35], v[212:215], v[188:191]
    ds_read_b64_tr_b16 v[220:221], v3 offset:1280
    v_mfma_f32_16x16x32_bf16 v[192:195], v[48:51], v[212:215], v[192:195]
    ds_read_b64_tr_b16 v[222:223], v3 offset:1296
    v_mfma_f32_16x16x32_bf16 v[140:143], v[224:227], v[236:239], v[140:143]
    ds_read_b128 v[232:235], v244 offset:3584
    v_mfma_f32_16x16x32_bf16 v[196:199], v[64:67], v[212:215], v[196:199]
    ds_read_b64_tr_b16 v[224:225], v3 offset:1408
    v_mfma_f32_16x16x32_bf16 v[200:203], v[80:83], v[212:215], v[200:203]
    ds_read_b64_tr_b16 v[226:227], v3 offset:1424
    s_branch L_mt_f
.p2align 12
L_mv3_f:
    v_mov_b32 v10, 141396
    s_mov_b32 s85, 2097152
L_mwx03:
    ds_read_b32 v11, v10
    s_sub_u32 s85, s85, 1
    s_cbranch_scc1 L_end
    s_waitcnt lgkmcnt(0)
    v_readfirstlane_b32 s60, v11
    s_and_b32 s61, s60, 0xff
    s_cmp_ge_u32 s61, 4
    s_cbranch_scc0 L_mwx03
    ds_read_b128 v[208:211], v246 offset:14336
    ds_read_b128 v[212:215], v247 offset:14336
    s_cmp_ge_u32 s60, 0x100
    s_cbranch_scc1 L_Mslow
    s_waitcnt lgkmcnt(1)
    v_mfma_f32_16x16x32_bf16 v[144:147], v[16:19], v[208:211], 0
    ds_read_b64_tr_b16 v[216:217], v3 offset:0
    v_mfma_f32_16x16x32_bf16 v[148:151], v[32:35], v[208:211], 0
    ds_read_b64_tr_b16 v[218:219], v3 offset:16
    v_mfma_f32_16x16x32_bf16 v[152:155], v[48:51], v[208:211], 0
    ds_read_b128 v[228:231], v242 offset:1536
    v_mfma_f32_16x16x32_bf16 v[156:159], v[64:67], v[208:211], 0
    ds_read_b64_tr_b16 v[220:221], v3 offset:128
    v_mfma_f32_16x16x32_bf16 v[160:163], v[80:83], v[208:211], 0
    ds_read_b64_tr_b16 v[222:223], v3 offset:144
    v_mfma_f32_16x16x32_bf16 v[164:167], v[96:99], v[208:211], 0
    ds_read_b128 v[232:235], v243 offset:1536
    v_mfma_f32_16x16x32_bf16 v[168:171], v[112:115], v[208:211], 0
    s_waitcnt lgkmcnt(3)
    ds_read_b64_tr_b16 v[224:225], v3 offset:256
    v_mfma_f32_16x16x32_bf16 v[12:15], v[216:219], v[228:231], 0
    ds_read_b64_tr_b16 v[226:227], v3 offset:272
    v_mfma_f32_16x16x32_bf16 v[172:175], v[128:131], v[208:211], 0
    ds_read_b128 v[236:239], v244 offset:1536
    v_mfma_f32_16x16x32_bf16 v[176:179], v[16:19], v[212:215], 0
    ds_read_b128 v[208:211], v248 offset:14336
    v_mfma_f32_16x16x32_bf16 v[180:183], v[32:35], v[212:215], 0
    s_waitcnt lgkmcnt(4)
    ds_read_b64_tr_b16 v[216:217], v3 offset:384
    v_mfma_f32_16x16x32_bf16 v[12:15], v[220:223], v[232:235], v[12:15]
    ds_read_b64_tr_b16 v[218:219], v3 offset:400
    v_mfma_f32_16x16x32_bf16 v[184:187], v[48:51], v[212:215], 0
    ds_read_b128 v[228:231], v245 offset:1536
    v_mfma_f32_16x16x32_bf16 v[188:191], v[64:67], v[212:215], 0
    ds_read_b64_tr_b16 v[220:221], v3 offset:512
    v_mfma_f32_16x16x32_bf16 v[192:195], v[80:83], v[212:215], 0
    ds_read_b64_tr_b16 v[222:223], v3 offset:528
    v_mfma_f32_16x16x32_bf16 v[196:199], v[96:99], v[212:215], 0
    s_waitcnt lgkmcnt(5)
    ds_read_b128 v[232:235], v242 offset:2048
    v_mfma_f32_16x16x32_bf16 v[12:15], v[224:227], v[236:239], v[12:15]
    v_mfma_f32_16x16x32_bf16 v[200:203], v[112:115], v[212:215], 0
    ds_read_b64_tr_b16 v[224:225], v3 offset:640
    v_mfma_f32_16x16x32_bf16 v[204:207], v[128:131], v[212:215], 0
    ds_read_b128 v[212:215], v249 offset:14336
    v_mfma_f32_16x16x32_bf16 v[144:147], v[20:23], v[208:211], v[144:147]
    ds_read_b64_tr_b16 v[226:227], v3 offset:656
    v_mfma_f32_16x16x32_bf16 v[148:151], v[36:39], v[208:211], v[148:151]
    s_waitcnt lgkmcnt(4)
    ds_read_b128 v[236:239], v243 offset:2048
    v_mfma_f32_16x16x32_bf16 v[12:15], v[216:219], v[228:231], v[12:15]
    ds_read_b64_tr_b16 v[216:217], v3 offset:768
    v_mfma_f32_16x16x32_bf16 v[152:155], v[52:55], v[208:211], v[152:155]
    ds_read_b64_tr_b16 v[218:219], v3 offset:784
    v_mfma_f32_16x16x32_bf16 v[156:159], v[68:71], v[208:211], v[156:159]
    ds_read_b128 v[228:231], v244 offset:2048
    v_mfma_f32_16x16x32_bf16 v[160:163], v[84:87], v[208:211], v[160:163]
    v_mfma_f32_16x16x32_bf16 v[164:167], v[100:103], v[208:211], v[164:167]
    s_waitcnt lgkmcnt(4)
    v_mfma_f32_16x16x32_bf16 v[12:15], v[220:223], v[232:235], v[12:15]
    ds_read_b64_tr_b16 v[220:221], v3 offset:896
    v_mfma_f32_16x16x32_bf16 v[168:171], v[116:119], v[208:211], v[168:171]
    ds_read_b64_tr_b16 v[222:223], v3 offset:912
    v_mfma_f32_16x16x32_bf16 v[172:175], v[132:135], v[208:211], v[172:175]
    ds_read_b128 v[208:211], v250 offset:14336
    v_mfma_f32_16x16x32_bf16 v[176:179], v[20:23], v[212:215], v[176:179]
    ds_read_b128 v[232:235], v245 offset:2048
    v_mfma_f32_16x16x32_bf16 v[180:183], v[36:39], v[212:215], v[180:183]
    s_waitcnt lgkmcnt(4)
    v_mfma_f32_16x16x32_bf16 v[12:15], v[224:227], v[236:239], v[12:15]
    ds_read_b64_tr_b16 v[224:225], v3 offset:1024
    v_mfma_f32_16x16x32_bf16 v[184:187], v[52:55], v[212:215], v[184:187]
    ds_read_b64_tr_b16 v[226:227], v3 offset:1040
    v_mfma_f32_16x16x32_bf16 v[188:191], v[68:71], v[212:215], v[188:191]
    ds_read_b128 v[236:239], v242 offset:2560
    v_mfma_f32_16x16x32_bf16 v[192:195], v[84:87], v[212:215], v[192:195]
    v_mfma_f32_16x16x32_bf16 v[12:15], v[216:219], v[228:231], v[12:15]
    v_mfma_f32_16x16x32_bf16 v[196:199], v[100:103], v[212:215], v[196:199]
    ds_read_b64_tr_b16 v[216:217], v3 offset:1152
    v_mfma_f32_16x16x32_bf16 v[200:203], v[116:119], v[212:215], v[200:203]
    ds_read_b64_tr_b16 v[218:219], v3 offset:1168
    v_mfma_f32_16x16x32_bf16 v[204:207], v[132:135], v[212:215], v[204:207]
    s_waitcnt lgkmcnt(3)
    ds_read_b128 v[212:215], v251 offset:14336
    v_mfma_f32_16x16x32_bf16 v[144:147], v[24:27], v[208:211], v[144:147]
    ds_read_b128 v[228:231], v243 offset:2560
    v_mfma_f32_16x16x32_bf16 v[12:15], v[220:223], v[232:235], v[12:15]
    v_mfma_f32_16x16x32_bf16 v[148:151], v[40:43], v[208:211], v[148:151]
    ds_read_b64_tr_b16 v[220:221], v3 offset:1280
    v_mfma_f32_16x16x32_bf16 v[152:155], v[56:59], v[208:211], v[152:155]
    ds_read_b64_tr_b16 v[222:223], v3 offset:1296
    v_mfma_f32_16x16x32_bf16 v[156:159], v[72:75], v[208:211], v[156:159]
    ds_read_b128 v[232:235], v244 offset:2560
    v_mfma_f32_16x16x32_bf16 v[160:163], v[88:91], v[208:211], v[160:163]
    s_waitcnt lgkmcnt(4)
    v_mfma_f32_16x16x32_bf16 v[12:15], v[224:227], v[236:239], v[12:15]
    v_mfma_f32_16x16x32_bf16 v[164:167], v[104:107], v[208:211], v[164:167]
    ds_read_b64_tr_b16 v[224:225], v3 offset:1408
    v_mfma_f32_16x16x32_bf16 v[168:171], v[120:123], v[208:211], v[168:171]
    ds_read_b64_tr_b16 v[226:227], v3 offset:1424
    v_mfma_f32_16x16x32_bf16 v[172:175], v[136:139], v[208:211], v[172:175]
    ds_read_b128 v[208:211], v252 offset:14336
    v_mfma_f32_16x16x32_bf16 v[176:179], v[24:27], v[212:215], v[176:179]
    s_waitcnt lgkmcnt(3)
    ds_read_b128 v[236:239], v245 offset:2560
    v_mfma_f32_16x16x32_bf16 v[12:15], v[216:219], v[228:231], v[12:15]
    ds_read_b64_tr_b16 v[216:217], v3 offset:1536
    v_mfma_f32_16x16x32_bf16 v[180:183], v[40:43], v[212:215], v[180:183]
    ds_read_b64_tr_b16 v[218:219], v3 offset:1552
    v_mfma_f32_16x16x32_bf16 v[184:187], v[56:59], v[212:215], v[184:187]
    ds_read_b128 v[228:231], v242 offset:3072
    v_mfma_f32_16x16x32_bf16 v[188:191], v[72:75], v[212:215], v[188:191]
    v_mfma_f32_16x16x32_bf16 v[192:195], v[88:91], v[212:215], v[192:195]
    v_mfma_f32_16x16x32_bf16 v[12:15], v[220:223], v[232:235], v[12:15]
    ds_read_b64_tr_b16 v[220:221], v3 offset:1664
    v_mfma_f32_16x16x32_bf16 v[196:199], v[104:107], v[212:215], v[196:199]
    ds_read_b64_tr_b16 v[222:223], v3 offset:1680
    v_mfma_f32_16x16x32_bf16 v[200:203], v[120:123], v[212:215], v[200:203]
    ds_read_b128 v[232:235], v243 offset:3072
    v_mfma_f32_16x16x32_bf16 v[204:207], v[136:139], v[212:215], v[204:207]
    s_waitcnt lgkmcnt(3)
    ds_read_b128 v[212:215], v253 offset:14336
    v_mfma_f32_16x16x32_bf16 v[144:147], v[28:31], v[208:211], v[144:147]
    v_mfma_f32_16x16x32_bf16 v[12:15], v[224:227], v[236:239], v[12:15]
    ds_read_b64_tr_b16 v[224:225], v3 offset:1792
    v_mfma_f32_16x16x32_bf16 v[148:151], v[44:47], v[208:211], v[148:151]
    ds_read_b64_tr_b16 v[226:227], v3 offset:1808
    v_mfma_f32_16x16x32_bf16 v[152:155], v[60:63], v[208:211], v[152:155]
    ds_read_b128 v[236:239], v244 offset:3072
    v_mfma_f32_16x16x32_bf16 v[156:159], v[76:79], v[208:211], v[156:159]
    v_mfma_f32_16x16x32_bf16 v[12:15], v[216:219], v[228:231], v[12:15]
    v_mfma_f32_16x16x32_bf16 v[160:163], v[92:95], v[208:211], v[160:163]
    ds_read_b64_tr_b16 v[216:217], v3 offset:1920
    v_mfma_f32_16x16x32_bf16 v[164:167], v[108:111], v[208:211], v[164:167]
    ds_read_b64_tr_b16 v[218:219], v3 offset:1936
    v_mfma_f32_16x16x32_bf16 v[168:171], v[124:127], v[208:211], v[168:171]
    ds_read_b128 v[228:231], v245 offset:3072
    v_mfma_f32_16x16x32_bf16 v[172:175], v[140:143], v[208:211], v[172:175]
    s_waitcnt lgkmcnt(3)
    ds_read_b128 v[208:211], v246 offset:12288
    v_mfma_f32_16x16x32_bf16 v[12:15], v[220:223], v[232:235], v[12:15]
    v_mfma_f32_16x16x32_bf16 v[176:179], v[28:31], v[212:215], v[176:179]
    ds_read_b64_tr_b16 v[220:221], v3 offset:2048
    v_mfma_f32_16x16x32_bf16 v[180:183], v[44:47], v[212:215], v[180:183]
    ds_read_b64_tr_b16 v[222:223], v3 offset:2064
    v_mfma_f32_16x16x32_bf16 v[184:187], v[60:63], v[212:215], v[184:187]
    ds_read_b128 v[232:235], v242 offset:3584
    v_mfma_f32_16x16x32_bf16 v[188:191], v[76:79], v[212:215], v[188:191]
    v_mfma_f32_16x16x32_bf16 v[12:15], v[224:227], v[236:239], v[12:15]
    v_mfma_f32_16x16x32_bf16 v[192:195], v[92:95], v[212:215], v[192:195]
    ds_read_b64_tr_b16 v[224:225], v3 offset:2176
    v_bfi_b32 v240, v5, 0, v179
    v_mfma_f32_16x16x32_bf16 v[196:199], v[108:111], v[212:215], v[196:199]
    ds_bpermute_b32 v240, v4, v240
    v_add_f32 v146, v146, v177
    v_mfma_f32_16x16x32_bf16 v[200:203], v[124:127], v[212:215], v[200:203]
    ds_read_b64_tr_b16 v[226:227], v3 offset:2192
    v_add_f32 v147, v147, v178
    v_mfma_f32_16x16x32_bf16 v[204:207], v[140:143], v[212:215], v[204:207]
    s_waitcnt lgkmcnt(3)
    ds_read_b128 v[212:215], v247 offset:12288
    v_add_f32 v145, v145, v176
    v_mfma_f32_16x16x32_bf16 v[12:15], v[216:219], v[228:231], v[12:15]
    ds_read_b128 v[236:239], v243 offset:3584
    v_cvt_pk_bf16_f32 v9, v146, v147
    v_mfma_f32_16x16x32_bf16 v[148:151], v[16:19], v[208:211], v[148:151]
    ds_read_b64_tr_b16 v[216:217], v3 offset:2304
    v_mfma_f32_16x16x32_bf16 v[152:155], v[32:35], v[208:211], v[152:155]
    s_waitcnt lgkmcnt(4)
    ds_read_b64_tr_b16 v[218:219], v3 offset:2320
    v_add_f32 v144, v144, v240
    v_mfma_f32_16x16x32_bf16 v[156:159], v[48:51], v[208:211], v[156:159]
    ds_read_b128 v[228:231], v244 offset:3584
    v_cvt_pk_bf16_f32 v8, v144, v145
    v_mfma_f32_16x16x32_bf16 v[160:163], v[64:67], v[208:211], v[160:163]
    v_mfma_f32_16x16x32_bf16 v[12:15], v[220:223], v[232:235], v[12:15]
    ds_read_b64_tr_b16 v[220:221], v3 offset:2432
    v_mfma_f32_16x16x32_bf16 v[164:167], v[80:83], v[208:211], v[164:167]
    ds_read_b64_tr_b16 v[222:223], v3 offset:2448
    v_mfma_f32_16x16x32_bf16 v[168:171], v[96:99], v[208:211], v[168:171]
    ds_read_b128 v[232:235], v245 offset:3584
    v_mfma_f32_16x16x32_bf16 v[172:175], v[112:115], v[208:211], v[172:175]
    s_waitcnt lgkmcnt(4)
    ds_read_b128 v[208:211], v248 offset:12288
    v_mfma_f32_16x16x32_bf16 v[180:183], v[16:19], v[212:215], v[180:183]
    v_mfma_f32_16x16x32_bf16 v[12:15], v[224:227], v[236:239], v[12:15]
    ds_read_b64_tr_b16 v[224:225], v3 offset:0
    v_mfma_f32_16x16x32_bf16 v[184:187], v[32:35], v[212:215], v[184:187]
    ds_read_b64_tr_b16 v[226:227], v3 offset:16
    v_mfma_f32_16x16x32_bf16 v[188:191], v[48:51], v[212:215], v[188:191]
    ds_read_b128 v[236:239], v242 offset:2048
    v_mfma_f32_16x16x32_bf16 v[192:195], v[64:67], v[212:215], v[192:195]
    s_waitcnt lgkmcnt(4)
    v_mfma_f32_16x16x32_bf16 v[12:15], v[216:219], v[228:231], v[12:15]
    v_mfma_f32_16x16x32_bf16 v[196:199], v[80:83], v[212:215], v[196:199]
    ds_read_b64_tr_b16 v[216:217], v3 offset:128
    v_mfma_f32_16x16x32_bf16 v[200:203], v[96:99], v[212:215], v[200:203]
    ds_read_b64_tr_b16 v[218:219], v3 offset:144
    v_mfma_f32_16x16x32_bf16 v[204:207], v[112:115], v[212:215], v[204:207]
    s_waitcnt lgkmcnt(3)
    ds_read_b128 v[212:215], v249 offset:12288
    v_mfma_f32_16x16x32_bf16 v[148:151], v[20:23], v[208:211], v[148:151]
    ds_read_b128 v[228:231], v243 offset:2048
    v_mfma_f32_16x16x32_bf16 v[12:15], v[220:223], v[232:235], v[12:15]
    v_mfma_f32_16x16x32_bf16 v[152:155], v[36:39], v[208:211], v[152:155]
    ds_read_b64_tr_b16 v[220:221], v3 offset:256
    v_mfma_f32_16x16x32_bf16 v[156:159], v[52:55], v[208:211], v[156:159]
    ds_read_b64_tr_b16 v[222:223], v3 offset:272
    v_mfma_f32_16x16x32_bf16 v[160:163], v[68:71], v[208:211], v[160:163]
    ds_read_b128 v[232:235], v244 offset:2048
    v_mfma_f32_16x16x32_bf16 v[164:167], v[84:87], v[208:211], v[164:167]
    s_waitcnt lgkmcnt(4)
    v_mfma_f32_16x16x32_bf16 v[140:143], v[224:227], v[236:239], 0
    v_mfma_f32_16x16x32_bf16 v[168:171], v[100:103], v[208:211], v[168:171]
    ds_read_b64_tr_b16 v[224:225], v3 offset:384
    v_mfma_f32_16x16x32_bf16 v[172:175], v[116:119], v[208:211], v[172:175]
    ds_read_b128 v[208:211], v250 offset:12288
    v_mfma_f32_16x16x32_bf16 v[180:183], v[20:23], v[212:215], v[180:183]
    ds_read_b64_tr_b16 v[226:227], v3 offset:400
    v_mfma_f32_16x16x32_bf16 v[184:187], v[36:39], v[212:215], v[184:187]
    s_waitcnt lgkmcnt(3)
    ds_read_b128 v[236:239], v245 offset:2048
    v_mfma_f32_16x16x32_bf16 v[140:143], v[216:219], v[228:231], v[140:143]
    ds_read_b64_tr_b16 v[216:217], v3 offset:512
    v_mfma_f32_16x16x32_bf16 v[188:191], v[52:55], v[212:215], v[188:191]
    ds_read_b64_tr_b16 v[218:219], v3 offset:528
    v_mfma_f32_16x16x32_bf16 v[192:195], v[68:71], v[212:215], v[192:195]
    ds_read_b128 v[228:231], v242 offset:2560
    v_mfma_f32_16x16x32_bf16 v[196:199], v[84:87], v[212:215], v[196:199]
    v_mfma_f32_16x16x32_bf16 v[200:203], v[100:103], v[212:215], v[200:203]
    v_mfma_f32_16x16x32_bf16 v[140:143], v[220:223], v[232:235], v[140:143]
    ds_read_b64_tr_b16 v[220:221], v3 offset:640
    v_mfma_f32_16x16x32_bf16 v[204:207], v[116:119], v[212:215], v[204:207]
    s_waitcnt lgkmcnt(3)
    ds_read_b128 v[212:215], v251 offset:12288
    v_mfma_f32_16x16x32_bf16 v[148:151], v[24:27], v[208:211], v[148:151]
    ds_read_b64_tr_b16 v[222:223], v3 offset:656
    v_mfma_f32_16x16x32_bf16 v[152:155], v[40:43], v[208:211], v[152:155]
    ds_read_b128 v[232:235], v243 offset:2560
    v_mfma_f32_16x16x32_bf16 v[156:159], v[56:59], v[208:211], v[156:159]
    v_mfma_f32_16x16x32_bf16 v[140:143], v[224:227], v[236:239], v[140:143]
    ds_read_b64_tr_b16 v[224:225], v3 offset:768
    v_mfma_f32_16x16x32_bf16 v[160:163], v[72:75], v[208:211], v[160:163]
    ds_read_b64_tr_b16 v[226:227], v3 offset:784
    v_mfma_f32_16x16x32_bf16 v[164:167], v[88:91], v[208:211], v[164:167]
    ds_read_b128 v[236:239], v244 offset:2560
    v_mfma_f32_16x16x32_bf16 v[168:171], v[104:107], v[208:211], v[168:171]
    s_waitcnt lgkmcnt(4)
    v_mfma_f32_16x16x32_bf16 v[140:143], v[216:219], v[228:231], v[140:143]
    v_mfma_f32_16x16x32_bf16 v[172:175], v[120:123], v[208:211], v[172:175]
    ds_read_b128 v[208:211], v252 offset:12288
    v_mfma_f32_16x16x32_bf16 v[180:183], v[24:27], v[212:215], v[180:183]
    ds_read_b64_tr_b16 v[216:217], v3 offset:896
    v_mfma_f32_16x16x32_bf16 v[184:187], v[40:43], v[212:215], v[184:187]
    ds_read_b64_tr_b16 v[218:219], v3 offset:912
    v_mfma_f32_16x16x32_bf16 v[188:191], v[56:59], v[212:215], v[188:191]
    s_waitcnt lgkmcnt(3)
    ds_read_b128 v[228:231], v245 offset:2560
    v_mfma_f32_16x16x32_bf16 v[140:143], v[220:223], v[232:235], v[140:143]
    v_mfma_f32_16x16x32_bf16 v[192:195], v[72:75], v[212:215], v[192:195]
    ds_read_b64_tr_b16 v[220:221], v3 offset:1024
    v_mfma_f32_16x16x32_bf16 v[196:199], v[88:91], v[212:215], v[196:199]
    ds_read_b64_tr_b16 v[222:223], v3 offset:1040
    v_mfma_f32_16x16x32_bf16 v[200:203], v[104:107], v[212:215], v[200:203]
    ds_read_b128 v[232:235], v242 offset:3072
    v_mfma_f32_16x16x32_bf16 v[204:207], v[120:123], v[212:215], v[204:207]
    ds_read_b128 v[212:215], v253 offset:12288
    v_mfma_f32_16x16x32_bf16 v[140:143], v[224:227], v[236:239], v[140:143]
    s_waitcnt lgkmcnt(4)
    v_mfma_f32_16x16x32_bf16 v[148:151], v[28:31], v[208:211], v[148:151]
    ds_read_b64_tr_b16 v[224:225], v3 offset:1152
    v_mfma_f32_16x16x32_bf16 v[152:155], v[44:47], v[208:211], v[152:155]
    ds_read_b64_tr_b16 v[226:227], v3 offset:1168
    v_mfma_f32_16x16x32_bf16 v[156:159], v[60:63], v[208:211], v[156:159]
    ds_read_b128 v[236:239], v243 offset:3072
    v_mfma_f32_16x16x32_bf16 v[160:163], v[76:79], v[208:211], v[160:163]
    v_mfma_f32_16x16x32_bf16 v[140:143], v[216:219], v[228:231], v[140:143]
    ds_read_b64_tr_b16 v[216:217], v3 offset:1280
    v_mfma_f32_16x16x32_bf16 v[164:167], v[92:95], v[208:211], v[164:167]
    ds_read_b64_tr_b16 v[218:219], v3 offset:1296
    v_mfma_f32_16x16x32_bf16 v[168:171], v[108:111], v[208:211], v[168:171]
    ds_read_b128 v[228:231], v244 offset:3072
    v_mfma_f32_16x16x32_bf16 v[172:175], v[124:127], v[208:211], v[172:175]
    s_waitcnt lgkmcnt(4)
    ds_read_b128 v[208:211], v246 offset:10240
    v_mfma_f32_16x16x32_bf16 v[180:183], v[28:31], v[212:215], v[180:183]
    v_mfma_f32_16x16x32_bf16 v[140:143], v[220:223], v[232:235], v[140:143]
    ds_read_b64_tr_b16 v[220:221], v3 offset:1408
    v_mfma_f32_16x16x32_bf16 v[184:187], v[44:47], v[212:215], v[184:187]
    ds_read_b64_tr_b16 v[222:223], v3 offset:1424
    v_mfma_f32_16x16x32_bf16 v[188:191], v[60:63], v[212:215], v[188:191]
    ds_read_b128 v[232:235], v245 offset:3072
    v_mfma_f32_16x16x32_bf16 v[192:195], v[76:79], v[212:215], v[192:195]
    v_mfma_f32_16x16x32_bf16 v[196:199], v[92:95], v[212:215], v[196:199]
    s_waitcnt lgkmcnt(3)
    v_bfi_b32 v241, v5, v179, v183
    v_add_f32 v150, v150, v181
    v_mfma_f32_16x16x32_bf16 v[140:143], v[224:227], v[236:239], v[140:143]
    ds_bpermute_b32 v241, v4, v241
    v_add_f32 v151, v151, v182
    v_mfma_f32_16x16x32_bf16 v[200:203], v[108:111], v[212:215], v[200:203]
    ds_read_b64_tr_b16 v[224:225], v3 offset:1536
    v_add_f32 v149, v149, v180
    v_mfma_f32_16x16x32_bf16 v[204:207], v[124:127], v[212:215], v[204:207]
    ds_read_b128 v[212:215], v247 offset:10240
    v_cvt_pk_bf16_f32 v11, v150, v151
    v_mfma_f32_16x16x32_bf16 v[152:155], v[16:19], v[208:211], v[152:155]
    ds_read_b64_tr_b16 v[226:227], v3 offset:1552
    v_mfma_f32_16x16x32_bf16 v[140:143], v[216:219], v[228:231], v[140:143]
    ds_read_b128 v[236:239], v242 offset:3584
    v_mfma_f32_16x16x32_bf16 v[156:159], v[32:35], v[208:211], v[156:159]
    s_waitcnt lgkmcnt(4)
    ds_read_b64_tr_b16 v[216:217], v3 offset:1664
    v_add_f32 v148, v148, v241
    v_mfma_f32_16x16x32_bf16 v[160:163], v[48:51], v[208:211], v[160:163]
    ds_read_b64_tr_b16 v[218:219], v3 offset:1680
    v_cvt_pk_bf16_f32 v10, v148, v149
    v_mfma_f32_16x16x32_bf16 v[164:167], v[64:67], v[208:211], v[164:167]
    ds_read_b128 v[228:231], v243 offset:3584
    v_permlane16_swap_b32 v9, v11
    v_mfma_f32_16x16x32_bf16 v[168:171], v[80:83], v[208:211], v[168:171]
    v_mfma_f32_16x16x32_bf16 v[140:143], v[220:223], v[232:235], v[140:143]
    v_permlane16_swap_b32 v8, v10
    v_mfma_f32_16x16x32_bf16 v[172:175], v[96:99], v[208:211], v[172:175]
    s_waitcnt lgkmcnt(3)
    buffer_store_dwordx4 v[8:11], v6, s[36:39], s52 offen
    v_mfma_f32_16x16x32_bf16 v[184:187], v[16:19], v[212:215], v[184:187]
    ds_read_b128 v[208:211], v248 offset:10240
    v_mfma_f32_16x16x32_bf16 v[188:191], v[32:35], v[212:215], v[188:191]
    ds_read_b64_tr_b16 v[220:221], v3 offset:1792
    v_mfma_f32_16x16x32_bf16 v[192:195], v[48:51], v[212:215], v[192:195]
    ds_read_b64_tr_b16 v[222:223], v3 offset:1808
    v_mfma_f32_16x16x32_bf16 v[140:143], v[224:227], v[236:239], v[140:143]
    ds_read_b128 v[232:235], v244 offset:3584
    v_mfma_f32_16x16x32_bf16 v[196:199], v[64:67], v[212:215], v[196:199]
    ds_read_b64_tr_b16 v[224:225], v3 offset:1920
    v_mfma_f32_16x16x32_bf16 v[200:203], v[80:83], v[212:215], v[200:203]
    ds_read_b64_tr_b16 v[226:227], v3 offset:1936
    s_branch L_mt_f
.p2align 12
T_mt_f:
    s_setpc_b64 s[0:1]
L_mt_f:
    v_mfma_f32_16x16x32_bf16 v[204:207], v[96:99], v[212:215], v[204:207]
    s_waitcnt lgkmcnt(5)
    ds_read_b128 v[212:215], v249 offset:10240
    v_mfma_f32_16x16x32_bf16 v[152:155], v[20:23], v[208:211], v[152:155]
    ds_read_b128 v[236:239], v245 offset:3584
    v_mfma_f32_16x16x32_bf16 v[140:143], v[216:219], v[228:231], v[140:143]
    v_mfma_f32_16x16x32_bf16 v[156:159], v[36:39], v[208:211], v[156:159]
    v_mfma_f32_16x16x32_bf16 v[160:163], v[52:55], v[208:211], v[160:163]
    v_mfma_f32_16x16x32_bf16 v[164:167], v[68:71], v[208:211], v[164:167]
    v_mfma_f32_16x16x32_bf16 v[168:171], v[84:87], v[208:211], v[168:171]
    s_waitcnt lgkmcnt(1)
    v_mfma_f32_16x16x32_bf16 v[140:143], v[220:223], v[232:235], v[140:143]
    v_mfma_f32_16x16x32_bf16 v[172:175], v[100:103], v[208:211], v[172:175]
    ds_read_b128 v[208:211], v250 offset:10240
    v_mfma_f32_16x16x32_bf16 v[184:187], v[20:23], v[212:215], v[184:187]
    v_mfma_f32_16x16x32_bf16 v[188:191], v[36:39], v[212:215], v[188:191]
    v_mfma_f32_16x16x32_bf16 v[192:195], v[52:55], v[212:215], v[192:195]
    s_waitcnt lgkmcnt(1)
    v_mfma_f32_16x16x32_bf16 v[140:143], v[224:227], v[236:239], v[140:143]
    v_mov_b32 v136, s99
    v_mov_b32 v137, 1
    v_mfma_f32_16x16x32_bf16 v[196:199], v[68:71], v[212:215], v[196:199]
    v_mov_b32 v138, s62
    v_mfma_f32_16x16x32_bf16 v[200:203], v[84:87], v[212:215], v[200:203]
    v_mfma_f32_16x16x32_bf16 v[204:207], v[100:103], v[212:215], v[204:207]
    s_waitcnt lgkmcnt(0)
    ds_read_b128 v[212:215], v251 offset:10240
    v_bfi_b32 v128, v138, v140, v12
    v_mfma_f32_16x16x32_bf16 v[152:155], v[24:27], v[208:211], v[152:155]
    v_bfi_b32 v129, v138, v141, v13
    v_bfi_b32 v130, v138, v142, v14
    v_mfma_f32_16x16x32_bf16 v[156:159], v[40:43], v[208:211], v[156:159]
    v_bfi_b32 v131, v138, v143, v15
    v_mfma_f32_16x16x32_bf16 v[160:163], v[56:59], v[208:211], v[160:163]
    ds_write_b128 v7, v[128:131]
    v_mfma_f32_16x16x32_bf16 v[164:167], v[72:75], v[208:211], v[164:167]
    s_mov_b64 exec, 1
    ds_add_u32 v136, v137
    s_mov_b64 exec, -1
    v_mfma_f32_16x16x32_bf16 v[168:171], v[88:91], v[208:211], v[168:171]
    v_bfi_b32 v132, v138, v12, v140
    v_bfi_b32 v133, v138, v13, v141
    v_mfma_f32_16x16x32_bf16 v[172:175], v[104:107], v[208:211], v[172:175]
    s_waitcnt lgkmcnt(2)
    ds_read_b128 v[208:211], v252 offset:10240
    v_bfi_b32 v134, v138, v14, v142
    v_mfma_f32_16x16x32_bf16 v[184:187], v[24:27], v[212:215], v[184:187]
    v_bfi_b32 v135, v138, v15, v143
    v_mfma_f32_16x16x32_bf16 v[188:191], v[40:43], v[212:215], v[188:191]
    ds_read_b32 v137, v136
    v_mfma_f32_16x16x32_bf16 v[192:195], v[56:59], v[212:215], v[192:195]
    ds_read_b128 v[216:219], v254
    v_mfma_f32_16x16x32_bf16 v[196:199], v[72:75], v[212:215], v[196:199]
    v_mfma_f32_16x16x32_bf16 v[200:203], v[88:91], v[212:215], v[200:203]
    v_mfma_f32_16x16x32_bf16 v[204:207], v[104:107], v[212:215], v[204:207]
    s_waitcnt lgkmcnt(2)
    ds_read_b128 v[212:215], v253 offset:10240
    v_mfma_f32_16x16x32_bf16 v[152:155], v[28:31], v[208:211], v[152:155]
    v_mfma_f32_16x16x32_bf16 v[156:159], v[44:47], v[208:211], v[156:159]
    s_waitcnt lgkmcnt(1)
    v_readfirstlane_b32 s60, v137
    s_cmp_lt_u32 s60, 2
    s_cbranch_scc1 L_zspin_f
L_zback_f:
    v_add_f32 v132, v132, v216
    v_mfma_f32_16x16x32_bf16 v[160:163], v[60:63], v[208:211], v[160:163]
    v_add_f32 v133, v133, v217
    v_add_f32 v134, v134, v218
    v_mfma_f32_16x16x32_bf16 v[164:167], v[76:79], v[208:211], v[164:167]
    v_add_f32 v135, v135, v219
    v_cvt_pk_bf16_f32 v138, v132, v133
    v_mfma_f32_16x16x32_bf16 v[168:171], v[92:95], v[208:211], v[168:171]
    v_cvt_pk_bf16_f32 v139, v134, v135
    v_mfma_f32_16x16x32_bf16 v[172:175], v[108:111], v[208:211], v[172:175]
    s_waitcnt lgkmcnt(0)
    ds_read_b128 v[208:211], v246 offset:8192
    v_mfma_f32_16x16x32_bf16 v[184:187], v[28:31], v[212:215], v[184:187]
    buffer_store_dwordx2 v[138:139], v255, s[48:51], s98 offen
    v_mfma_f32_16x16x32_bf16 v[188:191], v[44:47], v[212:215], v[188:191]
    v_mfma_f32_16x16x32_bf16 v[192:195], v[60:63], v[212:215], v[192:195]
    ds_read_b128 v[216:219], v248 offset:8192
    v_mfma_f32_16x16x32_bf16 v[196:199], v[76:79], v[212:215], v[196:199]
    v_mfma_f32_16x16x32_bf16 v[200:203], v[92:95], v[212:215], v[200:203]
    v_mfma_f32_16x16x32_bf16 v[204:207], v[108:111], v[212:215], v[204:207]
    s_waitcnt lgkmcnt(1)
    ds_read_b128 v[212:215], v247 offset:8192
    v_bfi_b32 v0, v5, v183, v187
    v_mfma_f32_16x16x32_bf16 v[156:159], v[16:19], v[208:211], v[156:159]
    ds_bpermute_b32 v0, v4, v0
    v_add_f32 v154, v154, v185
    v_mfma_f32_16x16x32_bf16 v[160:163], v[32:35], v[208:211], v[160:163]
    ds_read_b128 v[220:223], v249 offset:8192
    v_add_f32 v155, v155, v186
    v_mfma_f32_16x16x32_bf16 v[164:167], v[48:51], v[208:211], v[164:167]
    v_add_f32 v153, v153, v184
    v_cvt_pk_bf16_f32 v9, v154, v155
    v_mfma_f32_16x16x32_bf16 v[168:171], v[64:67], v[208:211], v[168:171]
    v_mfma_f32_16x16x32_bf16 v[172:175], v[80:83], v[208:211], v[172:175]
    s_waitcnt lgkmcnt(2)
    v_mfma_f32_16x16x32_bf16 v[188:191], v[16:19], v[212:215], v[188:191]
    s_waitcnt lgkmcnt(1)
    v_add_f32 v152, v152, v0
    v_cvt_pk_bf16_f32 v8, v152, v153
    v_mfma_f32_16x16x32_bf16 v[192:195], v[32:35], v[212:215], v[192:195]
    ds_read_b128 v[224:227], v250 offset:8192
    v_mfma_f32_16x16x32_bf16 v[196:199], v[48:51], v[212:215], v[196:199]
    v_mfma_f32_16x16x32_bf16 v[200:203], v[64:67], v[212:215], v[200:203]
    v_mfma_f32_16x16x32_bf16 v[204:207], v[80:83], v[212:215], v[204:207]
    v_mfma_f32_16x16x32_bf16 v[156:159], v[20:23], v[216:219], v[156:159]
    v_mfma_f32_16x16x32_bf16 v[160:163], v[36:39], v[216:219], v[160:163]
    v_mov_b32 v136, 1
    s_waitcnt vmcnt(0)
    buffer_store_dword v136, off, s[40:43], s97 offset:1024
    v_mfma_f32_16x16x32_bf16 v[164:167], v[52:55], v[216:219], v[164:167]
    ds_read_b128 v[228:231], v251 offset:8192
    v_mfma_f32_16x16x32_bf16 v[168:171], v[68:71], v[216:219], v[168:171]
    v_mfma_f32_16x16x32_bf16 v[172:175], v[84:87], v[216:219], v[172:175]
    s_waitcnt lgkmcnt(1)
    v_mfma_f32_16x16x32_bf16 v[188:191], v[20:23], v[220:223], v[188:191]
    v_mfma_f32_16x16x32_bf16 v[192:195], v[36:39], v[220:223], v[192:195]
    ds_read_b128 v[232:235], v252 offset:8192
    v_mfma_f32_16x16x32_bf16 v[196:199], v[52:55], v[220:223], v[196:199]
    v_mfma_f32_16x16x32_bf16 v[200:203], v[68:71], v[220:223], v[200:203]
    v_mfma_f32_16x16x32_bf16 v[204:207], v[84:87], v[220:223], v[204:207]
    v_mfma_f32_16x16x32_bf16 v[156:159], v[24:27], v[224:227], v[156:159]
    v_mfma_f32_16x16x32_bf16 v[160:163], v[40:43], v[224:227], v[160:163]
    ds_read_b128 v[236:239], v253 offset:8192
    v_mfma_f32_16x16x32_bf16 v[164:167], v[56:59], v[224:227], v[164:167]
    v_mfma_f32_16x16x32_bf16 v[168:171], v[72:75], v[224:227], v[168:171]
    v_mfma_f32_16x16x32_bf16 v[172:175], v[88:91], v[224:227], v[172:175]
    s_waitcnt lgkmcnt(1)
    ds_read_b32 v2, v1
    v_mfma_f32_16x16x32_bf16 v[188:191], v[24:27], v[228:231], v[188:191]
    v_mfma_f32_16x16x32_bf16 v[192:195], v[40:43], v[228:231], v[192:195]
    v_mfma_f32_16x16x32_bf16 v[196:199], v[56:59], v[228:231], v[196:199]
    v_mfma_f32_16x16x32_bf16 v[200:203], v[72:75], v[228:231], v[200:203]
    v_mfma_f32_16x16x32_bf16 v[204:207], v[88:91], v[228:231], v[204:207]
    v_mfma_f32_16x16x32_bf16 v[156:159], v[28:31], v[232:235], v[156:159]
    v_mfma_f32_16x16x32_bf16 v[160:163], v[44:47], v[232:235], v[160:163]
    s_waitcnt lgkmcnt(0)
    v_readfirstlane_b32 s60, v2
    s_cmp_lt_u32 s60, 4
    s_cbranch_scc1 L_mspin_f
L_mback_f:
    v_mfma_f32_16x16x32_bf16 v[164:167], v[60:63], v[232:235], v[164:167]
    ds_read_b128 v[208:211], v246 offset:6144
    v_mfma_f32_16x16x32_bf16 v[168:171], v[76:79], v[232:235], v[168:171]
    ds_read_b128 v[212:215], v247 offset:6144
    v_mfma_f32_16x16x32_bf16 v[172:175], v[92:95], v[232:235], v[172:175]
    ds_read_b128 v[216:219], v248 offset:6144
    v_mfma_f32_16x16x32_bf16 v[188:191], v[28:31], v[236:239], v[188:191]
    v_mfma_f32_16x16x32_bf16 v[192:195], v[44:47], v[236:239], v[192:195]
    v_mfma_f32_16x16x32_bf16 v[196:199], v[60:63], v[236:239], v[196:199]
    v_mfma_f32_16x16x32_bf16 v[200:203], v[76:79], v[236:239], v[200:203]
    ds_read_b128 v[220:223], v249 offset:6144
    v_mfma_f32_16x16x32_bf16 v[204:207], v[92:95], v[236:239], v[204:207]
    s_waitcnt lgkmcnt(2)
    v_mfma_f32_16x16x32_bf16 v[160:163], v[16:19], v[208:211], v[160:163]
    v_mfma_f32_16x16x32_bf16 v[164:167], v[32:35], v[208:211], v[164:167]
    v_bfi_b32 v240, v5, v187, v191
    v_add_f32 v158, v158, v189
    v_mfma_f32_16x16x32_bf16 v[168:171], v[48:51], v[208:211], v[168:171]
    ds_bpermute_b32 v240, v4, v240
    v_add_f32 v159, v159, v190
    v_mfma_f32_16x16x32_bf16 v[172:175], v[64:67], v[208:211], v[172:175]
    ds_read_b128 v[224:227], v250 offset:6144
    v_add_f32 v157, v157, v188
    v_mfma_f32_16x16x32_bf16 v[192:195], v[16:19], v[212:215], v[192:195]
    v_cvt_pk_bf16_f32 v11, v158, v159
    v_mfma_f32_16x16x32_bf16 v[196:199], v[32:35], v[212:215], v[196:199]
    v_mfma_f32_16x16x32_bf16 v[200:203], v[48:51], v[212:215], v[200:203]
    ds_read_b128 v[228:231], v251 offset:6144
    v_mfma_f32_16x16x32_bf16 v[204:207], v[64:67], v[212:215], v[204:207]
    s_waitcnt lgkmcnt(3)
    s_waitcnt lgkmcnt(2)
    v_add_f32 v156, v156, v240
    v_cvt_pk_bf16_f32 v10, v156, v157
    v_mfma_f32_16x16x32_bf16 v[160:163], v[20:23], v[216:219], v[160:163]
    v_permlane16_swap_b32 v9, v11
    v_mfma_f32_16x16x32_bf16 v[164:167], v[36:39], v[216:219], v[164:167]
    v_mfma_f32_16x16x32_bf16 v[168:171], v[52:55], v[216:219], v[168:171]
    ds_read_b128 v[232:235], v252 offset:6144
    v_permlane16_swap_b32 v8, v10
    v_mfma_f32_16x16x32_bf16 v[172:175], v[68:71], v[216:219], v[172:175]
    buffer_store_dwordx4 v[8:11], v6, s[36:39], s53 offen
    v_mfma_f32_16x16x32_bf16 v[192:195], v[20:23], v[220:223], v[192:195]
    ds_read_b128 v[80:83], v246 offset:2048
    v_mfma_f32_16x16x32_bf16 v[196:199], v[36:39], v[220:223], v[196:199]
    v_mfma_f32_16x16x32_bf16 v[200:203], v[52:55], v[220:223], v[200:203]
    ds_read_b128 v[236:239], v253 offset:6144
    v_mfma_f32_16x16x32_bf16 v[204:207], v[68:71], v[220:223], v[204:207]
    s_waitcnt lgkmcnt(3)
    ds_read_b128 v[84:87], v247 offset:2048
    v_mfma_f32_16x16x32_bf16 v[160:163], v[24:27], v[224:227], v[160:163]
    ds_read_b128 v[88:91], v248 offset:2048
    v_mfma_f32_16x16x32_bf16 v[164:167], v[40:43], v[224:227], v[164:167]
    v_mfma_f32_16x16x32_bf16 v[168:171], v[56:59], v[224:227], v[168:171]
    ds_read_b128 v[208:211], v246 offset:4096
    v_mfma_f32_16x16x32_bf16 v[172:175], v[72:75], v[224:227], v[172:175]
    ds_read_b128 v[92:95], v249 offset:2048
    v_mfma_f32_16x16x32_bf16 v[192:195], v[24:27], v[228:231], v[192:195]
    ds_read_b128 v[96:99], v250 offset:2048
    v_mfma_f32_16x16x32_bf16 v[196:199], v[40:43], v[228:231], v[196:199]
    ds_read_b128 v[212:215], v247 offset:4096
    v_mfma_f32_16x16x32_bf16 v[200:203], v[56:59], v[228:231], v[200:203]
    ds_read_b128 v[100:103], v251 offset:2048
    v_mfma_f32_16x16x32_bf16 v[204:207], v[72:75], v[228:231], v[204:207]
    s_waitcnt lgkmcnt(5)
    v_mfma_f32_16x16x32_bf16 v[160:163], v[28:31], v[232:235], v[160:163]
    ds_read_b128 v[216:219], v248 offset:4096
    v_mfma_f32_16x16x32_bf16 v[164:167], v[44:47], v[232:235], v[164:167]
    ds_read_b128 v[104:107], v252 offset:2048
    v_mfma_f32_16x16x32_bf16 v[168:171], v[60:63], v[232:235], v[168:171]
    ds_read_b128 v[108:111], v253 offset:2048
    v_mfma_f32_16x16x32_bf16 v[172:175], v[76:79], v[232:235], v[172:175]
    ds_read_b128 v[220:223], v249 offset:4096
    v_mfma_f32_16x16x32_bf16 v[192:195], v[28:31], v[236:239], v[192:195]
    ds_read_b128 v[112:115], v246 offset:0
    v_mfma_f32_16x16x32_bf16 v[196:199], v[44:47], v[236:239], v[196:199]
    v_mfma_f32_16x16x32_bf16 v[200:203], v[60:63], v[236:239], v[200:203]
    ds_read_b128 v[224:227], v250 offset:4096
    v_mfma_f32_16x16x32_bf16 v[204:207], v[76:79], v[236:239], v[204:207]
    s_waitcnt lgkmcnt(4)
    ds_read_b128 v[116:119], v247 offset:0
    v_mfma_f32_16x16x32_bf16 v[164:167], v[16:19], v[208:211], v[164:167]
    ds_read_b128 v[120:123], v248 offset:0
    v_bfi_b32 v241, v5, v191, v195
    v_mfma_f32_16x16x32_bf16 v[168:171], v[32:35], v[208:211], v[168:171]
    ds_bpermute_b32 v241, v4, v241
    v_add_f32 v162, v162, v193
    v_mfma_f32_16x16x32_bf16 v[172:175], v[48:51], v[208:211], v[172:175]
    ds_read_b128 v[228:231], v251 offset:4096
    v_add_f32 v163, v163, v194
    v_mfma_f32_16x16x32_bf16 v[196:199], v[16:19], v[212:215], v[196:199]
    ds_read_b128 v[124:127], v249 offset:0
    v_add_f32 v161, v161, v192
    v_mfma_f32_16x16x32_bf16 v[200:203], v[32:35], v[212:215], v[200:203]
    ds_read_b128 v[232:235], v252 offset:4096
    v_cvt_pk_bf16_f32 v9, v162, v163
    v_mfma_f32_16x16x32_bf16 v[204:207], v[48:51], v[212:215], v[204:207]
    ds_read_b128 v[128:131], v250 offset:0
    v_mfma_f32_16x16x32_bf16 v[164:167], v[20:23], v[216:219], v[164:167]
    s_waitcnt lgkmcnt(4)
    ds_read_b128 v[132:135], v251 offset:0
    v_add_f32 v160, v160, v241
    v_mfma_f32_16x16x32_bf16 v[168:171], v[36:39], v[216:219], v[168:171]
    ds_read_b128 v[236:239], v253 offset:4096
    v_cvt_pk_bf16_f32 v8, v160, v161
    v_mfma_f32_16x16x32_bf16 v[172:175], v[52:55], v[216:219], v[172:175]
    ds_read_b128 v[136:139], v252 offset:0
    v_mfma_f32_16x16x32_bf16 v[196:199], v[20:23], v[220:223], v[196:199]
    v_mfma_f32_16x16x32_bf16 v[200:203], v[36:39], v[220:223], v[200:203]
    ds_read_b128 v[140:143], v253 offset:0
    v_mfma_f32_16x16x32_bf16 v[204:207], v[52:55], v[220:223], v[204:207]
    v_mfma_f32_16x16x32_bf16 v[164:167], v[24:27], v[224:227], v[164:167]
    v_mfma_f32_16x16x32_bf16 v[168:171], v[40:43], v[224:227], v[168:171]
    v_mfma_f32_16x16x32_bf16 v[172:175], v[56:59], v[224:227], v[172:175]
    s_waitcnt lgkmcnt(1)
    v_mfma_f32_16x16x32_bf16 v[196:199], v[24:27], v[228:231], v[196:199]
    v_mfma_f32_16x16x32_bf16 v[200:203], v[40:43], v[228:231], v[200:203]
    v_mfma_f32_16x16x32_bf16 v[204:207], v[56:59], v[228:231], v[204:207]
    v_mfma_f32_16x16x32_bf16 v[164:167], v[28:31], v[232:235], v[164:167]
    v_mfma_f32_16x16x32_bf16 v[168:171], v[44:47], v[232:235], v[168:171]
    v_mfma_f32_16x16x32_bf16 v[172:175], v[60:63], v[232:235], v[172:175]
    v_mfma_f32_16x16x32_bf16 v[196:199], v[28:31], v[236:239], v[196:199]
    v_mfma_f32_16x16x32_bf16 v[200:203], v[44:47], v[236:239], v[200:203]
    v_mfma_f32_16x16x32_bf16 v[204:207], v[60:63], v[236:239], v[204:207]
    v_mfma_f32_16x16x32_bf16 v[200:203], v[16:19], v[84:87], v[200:203]
    v_mfma_f32_16x16x32_bf16 v[200:203], v[20:23], v[92:95], v[200:203]
    v_mfma_f32_16x16x32_bf16 v[200:203], v[24:27], v[100:103], v[200:203]
    v_mfma_f32_16x16x32_bf16 v[200:203], v[28:31], v[108:111], v[200:203]
    v_mfma_f32_16x16x32_bf16 v[168:171], v[16:19], v[80:83], v[168:171]
    v_mfma_f32_16x16x32_bf16 v[168:171], v[20:23], v[88:91], v[168:171]
    v_bfi_b32 v0, v5, v195, v199
    v_add_f32 v166, v166, v197
    v_mfma_f32_16x16x32_bf16 v[168:171], v[24:27], v[96:99], v[168:171]
    ds_bpermute_b32 v0, v4, v0
    v_add_f32 v167, v167, v198
    v_mfma_f32_16x16x32_bf16 v[168:171], v[28:31], v[104:107], v[168:171]
    v_bfi_b32 v240, v5, v199, v203
    v_add_f32 v165, v165, v196
    v_mfma_f32_16x16x32_bf16 v[204:207], v[32:35], v[84:87], v[204:207]
    ds_bpermute_b32 v240, v4, v240
    v_cvt_pk_bf16_f32 v11, v166, v167
    v_mfma_f32_16x16x32_bf16 v[204:207], v[36:39], v[92:95], v[204:207]
    v_mfma_f32_16x16x32_bf16 v[204:207], v[40:43], v[100:103], v[204:207]
    v_mfma_f32_16x16x32_bf16 v[204:207], v[44:47], v[108:111], v[204:207]
    s_waitcnt lgkmcnt(1)
    v_add_f32 v164, v164, v0
    v_cvt_pk_bf16_f32 v10, v164, v165
    v_mfma_f32_16x16x32_bf16 v[204:207], v[16:19], v[116:119], v[204:207]
    v_permlane16_swap_b32 v9, v11
    v_mfma_f32_16x16x32_bf16 v[204:207], v[20:23], v[124:127], v[204:207]
    v_mfma_f32_16x16x32_bf16 v[204:207], v[24:27], v[132:135], v[204:207]
    v_permlane16_swap_b32 v8, v10
    v_mfma_f32_16x16x32_bf16 v[204:207], v[28:31], v[140:143], v[204:207]
    buffer_store_dwordx4 v[8:11], v6, s[36:39], s54 offen
    v_add_f32 v170, v170, v201
    v_mfma_f32_16x16x32_bf16 v[172:175], v[32:35], v[80:83], v[172:175]
    v_add_f32 v171, v171, v202
    v_add_f32 v169, v169, v200
    v_mfma_f32_16x16x32_bf16 v[172:175], v[36:39], v[88:91], v[172:175]
    v_cvt_pk_bf16_f32 v9, v170, v171
    v_mfma_f32_16x16x32_bf16 v[172:175], v[40:43], v[96:99], v[172:175]
    s_waitcnt lgkmcnt(0)
    v_bfi_b32 v241, v5, v203, v207
    v_add_f32 v168, v168, v240
    v_mfma_f32_16x16x32_bf16 v[172:175], v[44:47], v[104:107], v[172:175]
    ds_bpermute_b32 v241, v4, v241
    v_cvt_pk_bf16_f32 v8, v168, v169
    v_mfma_f32_16x16x32_bf16 v[172:175], v[16:19], v[112:115], v[172:175]
    v_mfma_f32_16x16x32_bf16 v[172:175], v[20:23], v[120:123], v[172:175]
    v_mfma_f32_16x16x32_bf16 v[172:175], v[24:27], v[128:131], v[172:175]
    v_mfma_f32_16x16x32_bf16 v[172:175], v[28:31], v[136:139], v[172:175]
    s_nop 7
    v_add_f32 v174, v174, v205
    v_add_f32 v175, v175, v206
    v_add_f32 v173, v173, v204
    v_cvt_pk_bf16_f32 v11, v174, v175
    s_waitcnt lgkmcnt(0)
    v_add_f32 v172, v172, v241
    v_cvt_pk_bf16_f32 v10, v172, v173
    v_permlane16_swap_b32 v9, v11
    s_nop 0
    v_permlane16_swap_b32 v8, v10
    buffer_store_dwordx4 v[8:11], v6, s[36:39], s55 offen
    v_mov_b32 v0, 2
    s_waitcnt vmcnt(0)
    buffer_store_dword v0, off, s[40:43], s97 offset:512
    s_endpgm
L_mspin_f:
    v_mov_b32 v1, 141404
    s_mov_b32 s85, 2097152
L_mwx1_f:
    ds_read_b32 v2, v1
    s_sub_u32 s85, s85, 1
    s_cbranch_scc1 L_end
    s_waitcnt lgkmcnt(0)
    v_readfirstlane_b32 s60, v2
    s_and_b32 s61, s60, 0xff
    s_cmp_ge_u32 s61, 4
    s_cbranch_scc0 L_mwx1_f
    s_branch L_mback_f
L_zspin_f:
    s_mov_b32 s85, 2097152
L_zs2_f:
    ds_read_b32 v137, v136
    ds_read_b128 v[216:219], v254
    s_sub_u32 s85, s85, 1
    s_cbranch_scc1 L_end
    s_waitcnt lgkmcnt(0)
    v_readfirstlane_b32 s60, v137
    s_cmp_lt_u32 s60, 2
    s_cbranch_scc1 L_zs2_f
    s_branch L_zback_f
L_end:
    s_endpgm
L_codeend:
L_Hslow:
    s_mul_i32 s38, s6, 1152
    s_add_u32 s38, s38, s56
    s_add_u32 s36, s38, 8388608
    s_add_u32 s36, s24, s36
    s_addc_u32 s37, s25, 0
    s_sub_u32 s38, 4718592, s38
    s_mov_b32 s39, 0x00020000
    s_lshl_b32 s16, s4, 17
    s_add_u32 s16, s16, 2097152
    s_add_u32 s16, s24, s16
    s_addc_u32 s17, s25, 0
    s_mov_b32 s18, 131072
    s_mov_b32 s19, 0x00020000
    s_lshl_b32 s40, s4, 11
    s_add_u32 s40, s40, 16842752
    s_add_u32 s40, s24, s40
    s_addc_u32 s41, s25, 0
    s_mov_b32 s42, 2048
    s_mov_b32 s43, 0x00020000
    s_call_b64 s[0:1], L_p1_s
    s_waitcnt vmcnt(0)
    v_mov_b32 v10, 141320
    v_mov_b32 v11, 1
    s_mov_b64 exec, 1
    ds_add_rtn_u32 v12, v10, v11
    s_mov_b64 exec, -1
    v_mov_b32 v10, 1
    s_waitcnt lgkmcnt(0)
    v_readfirstlane_b32 s60, v12
    s_cmp_lg_u32 s60, 3
    s_cbranch_scc1 L_np0_s
    buffer_store_byte v10, off, s[40:43], s5 sc1
L_np0_s:
    s_mov_b32 s85, 2097152
    v_and_b32 v13, 28, v231
L_px0_s:
    buffer_load_dword v12, v13, s[40:43], 0 offen sc1
    s_sub_u32 s85, s85, 1
    s_cbranch_scc1 L_end
    s_waitcnt vmcnt(0)
    v_and_b32 v12, 16843009, v12
    v_cmp_eq_u32 vcc, 16843009, v12
    s_cmp_eq_u64 vcc, exec
    s_cbranch_scc0 L_px0_s
    s_lshl_b32 s61, s7, 11
    s_add_u32 m0, s61, 108032
    s_add_u32 s60, s97, 2064384
    buffer_load_dwordx4 v225, s[36:39], s60 offen sc1 lds
    s_add_u32 m0, s61, 109056
    s_add_u32 s60, s97, 1769472
    buffer_load_dwordx4 v226, s[36:39], s60 offen sc1 lds
    s_lshl_b32 s60, s7, 10
    s_add_u32 m0, s60, 118272
    s_add_u32 s60, s60, s91
    buffer_load_dwordx4 v65, s[16:19], s60 offen sc1 lds
    v_mov_b32 v10, 141396
    v_mov_b32 v11, 257
    s_mov_b64 exec, 1
    s_waitcnt vmcnt(0)
    ds_add_u32 v10, v11
    s_mov_b64 exec, -1
    v_mov_b32 v10, 141396
    s_mov_b32 s85, 2097152
L_wx0_s:
    ds_read_b32 v11, v10
    s_sub_u32 s85, s85, 1
    s_cbranch_scc1 L_end
    s_waitcnt lgkmcnt(0)
    v_readfirstlane_b32 s60, v11
    s_and_b32 s61, s60, 0xff
    s_cmp_ge_u32 s61, 4
    s_cbranch_scc0 L_wx0_s
    s_add_u32 s58, s58, 1179648
    s_add_u32 s59, s59, 1179648
    s_add_u32 s86, s57, 1175040
    s_add_u32 m0, s62, 25600
    s_nop 0
    buffer_load_dwordx4 v2, s[28:31], s58 offen  lds
    s_add_u32 m0, s62, 29696
    s_nop 0
    buffer_load_dwordx4 v2, s[28:31], s59 offen  lds
    s_cmp_lg_u32 s7, 3
    s_cbranch_scc1 L_nh3378
    s_mov_b32 m0, 24576
    s_nop 0
    buffer_load_dwordx4 v2, s[28:31], s86 offen  lds
L_nh3378:
    s_add_u32 m0, s62, 36864
    s_nop 0
    buffer_load_dwordx4 v2, s[12:15], s58 offen  lds
    s_add_u32 m0, s62, 40960
    s_nop 0
    buffer_load_dwordx4 v2, s[12:15], s59 offen  lds
    s_add_u32 s87, s87, 2359296
    s_add_u32 s88, s88, 2359296
    s_waitcnt vmcnt(0)
    s_mul_i32 s60, s5, 73728
    s_add_u32 s60, s60, 2359296
    buffer_load_dword v242, v241, s[36:39], s60 offen sc1
    s_sub_u32 s60, s57, s56
    s_add_u32 s60, s60, s101
    buffer_load_dwordx4 v[212:215], v76, s[48:51], s60 offen
    s_add_u32 s60, s60, 1179648
    buffer_load_dwordx4 v[216:219], v76, s[48:51], s60 offen
    s_waitcnt vmcnt(3)
    v_mov_b32 v10, 141400
    v_mov_b32 v11, 1
    s_mov_b64 exec, 1
    ds_add_u32 v10, v11
    s_mov_b64 exec, -1
    v_mov_b32 v10, 141400
    s_mov_b32 s85, 2097152
L_wkv1_s:
    ds_read_b32 v11, v10
    s_sub_u32 s85, s85, 1
    s_cbranch_scc1 L_end
    s_waitcnt lgkmcnt(0)
    v_readfirstlane_b32 s60, v11
    s_and_b32 s61, s60, 0xff
    s_cmp_ge_u32 s61, 4
    s_cbranch_scc0 L_wkv1_s
    ds_read_b128 v[80:83], v234 offset:26624
    ds_read_b128 v[88:91], v238 offset:38912
    ds_read_b128 v[84:87], v236 offset:26624
    ds_read_b128 v[92:95], v234 offset:24576
    ds_read_b128 v[100:103], v238 offset:36864
    ds_read_b128 v[96:99], v236 offset:24576
    ds_read_b128 v[104:107], v235 offset:26624
    ds_read_b128 v[112:115], v239 offset:38912
    ds_read_b128 v[108:111], v237 offset:26624
    ds_read_b128 v[116:119], v235 offset:24576
    ds_read_b128 v[124:127], v239 offset:36864
    ds_read_b128 v[120:123], v237 offset:24576
    s_waitcnt lgkmcnt(9)
    v_mfma_f32_16x16x32_bf16 v[152:155], v[80:83], v[36:39], 0
    v_mfma_f32_16x16x32_bf16 v[156:159], v[88:91], v[24:27], 0
    v_mfma_f32_16x16x32_bf16 v[152:155], v[84:87], v[40:43], v[152:155]
    s_waitcnt lgkmcnt(6)
    v_mfma_f32_16x16x32_bf16 v[160:163], v[92:95], v[36:39], 0
    v_mfma_f32_16x16x32_bf16 v[164:167], v[100:103], v[24:27], 0
    v_mfma_f32_16x16x32_bf16 v[160:163], v[96:99], v[40:43], v[160:163]
    s_waitcnt lgkmcnt(3)
    v_mfma_f32_16x16x32_bf16 v[168:171], v[104:107], v[44:47], 0
    s_nop 1
    v_mul_f32 v152, v152, v156
    v_mul_f32 v153, v153, v157
    v_mul_f32 v154, v154, v158
    v_mul_f32 v155, v155, v159
    v_mfma_f32_16x16x32_bf16 v[172:175], v[112:115], v[24:27], 0
    v_cvt_pk_bf16_f32 v176, v152, v153
    v_cvt_pk_bf16_f32 v177, v154, v155
    v_mfma_f32_16x16x32_bf16 v[168:171], v[108:111], v[48:51], v[168:171]
    s_waitcnt lgkmcnt(0)
    v_mfma_f32_16x16x32_bf16 v[152:155], v[116:119], v[44:47], 0
    v_mul_f32 v160, v160, v164
    v_mul_f32 v161, v161, v165
    v_mul_f32 v162, v162, v166
    v_mul_f32 v163, v163, v167
    v_mfma_f32_16x16x32_bf16 v[156:159], v[124:127], v[24:27], 0
    v_cvt_pk_bf16_f32 v178, v160, v161
    v_cvt_pk_bf16_f32 v179, v162, v163
    v_mfma_f32_16x16x32_bf16 v[152:155], v[120:123], v[48:51], v[152:155]
    ds_write_b128 v71, v[176:179] offset:0
    ds_read_b128 v[184:187], v72 offset:0
    v_mul_f32 v168, v168, v172
    v_mul_f32 v169, v169, v173
    v_mul_f32 v170, v170, v174
    v_mul_f32 v171, v171, v175
    v_cvt_pk_bf16_f32 v180, v168, v169
    v_cvt_pk_bf16_f32 v181, v170, v171
    s_waitcnt lgkmcnt(0)
    buffer_store_dwordx4 v[184:187], v224, s[36:39], s87 offen sc1
    s_nop 1
    v_mul_f32 v152, v152, v156
    v_mul_f32 v153, v153, v157
    v_mul_f32 v154, v154, v158
    v_mul_f32 v155, v155, v159
    v_cvt_pk_bf16_f32 v182, v152, v153
    v_cvt_pk_bf16_f32 v183, v154, v155
    ds_write_b128 v71, v[180:183] offset:1024
    ds_read_b128 v[188:191], v72 offset:1024
    s_waitcnt lgkmcnt(0)
    buffer_store_dwordx4 v[188:191], v224, s[36:39], s88 offen sc1
    s_waitcnt vmcnt(0)
    v_mov_b32 v10, 141432
    v_mov_b32 v11, 1
    s_mov_b64 exec, 1
    ds_add_rtn_u32 v12, v10, v11
    s_mov_b64 exec, -1
    v_mov_b32 v10, 3
    s_waitcnt lgkmcnt(0)
    v_readfirstlane_b32 s60, v12
    s_cmp_lg_u32 s60, 3
    s_cbranch_scc1 L_np1_s
    buffer_store_byte v10, off, s[40:43], s5 sc1
L_np1_s:
    s_lshl_b32 s95, s5, 6
    s_mul_i32 s99, s7, 3072
    s_mov_b32 s85, 2097152
    v_and_b32 v13, 28, v231
L_px1_s:
    buffer_load_dword v12, v13, s[40:43], 0 offen sc1
    s_sub_u32 s85, s85, 1
    s_cbranch_scc1 L_end
    s_waitcnt vmcnt(0)
    v_and_b32 v12, 33686018, v12
    v_cmp_eq_u32 vcc, 33686018, v12
    s_cmp_eq_u64 vcc, exec
    s_cbranch_scc0 L_px1_s
    s_lshl_b32 s61, s7, 11
    s_add_u32 m0, s61, 99840
    s_add_u32 s60, s97, 4423680
    buffer_load_dwordx4 v225, s[36:39], s60 offen sc1 lds
    s_add_u32 m0, s61, 100864
    s_add_u32 s60, s97, 4128768
    buffer_load_dwordx4 v226, s[36:39], s60 offen sc1 lds
    s_waitcnt vmcnt(0)
    v_mov_b32 v10, 141404
    v_mov_b32 v11, 1
    s_mov_b64 exec, 1
    ds_add_u32 v10, v11
    s_mov_b64 exec, -1
    v_mov_b32 v10, 141404
    s_mov_b32 s85, 2097152
L_wx1_s:
    ds_read_b32 v11, v10
    s_sub_u32 s85, s85, 1
    s_cbranch_scc1 L_end
    s_waitcnt lgkmcnt(0)
    v_readfirstlane_b32 s60, v11
    s_and_b32 s61, s60, 0xff
    s_cmp_ge_u32 s61, 4
    s_cbranch_scc0 L_wx1_s
    s_lshl_b32 s60, s7, 6
    s_add_u32 s61, s57, 0
    s_add_u32 s60, s60, s61
    buffer_load_dwordx4 v[196:199], v75, s[48:51], s60 offen
    s_add_u32 s60, s60, 4608
    buffer_load_dwordx4 v[200:203], v75, s[48:51], s60 offen
    s_lshl_b32 s60, s7, 6
    s_add_u32 s61, s57, 1179648
    s_add_u32 s60, s60, s61
    buffer_load_dwordx4 v[204:207], v75, s[48:51], s60 offen
    s_add_u32 s60, s60, 4608
    buffer_load_dwordx4 v[208:211], v75, s[48:51], s60 offen
    s_cmp_lg_u32 s7, 3
    s_cbranch_scc1 L_np3x3_s
    v_lshlrev_b32 v120, 16, v212
    v_and_b32 v121, 0xffff0000, v212
    v_lshlrev_b32 v122, 16, v213
    v_and_b32 v123, 0xffff0000, v213
    v_lshlrev_b32 v124, 16, v214
    v_and_b32 v125, 0xffff0000, v214
    v_lshlrev_b32 v126, 16, v215
    v_and_b32 v127, 0xffff0000, v215
    v_lshlrev_b32 v128, 16, v216
    v_and_b32 v129, 0xffff0000, v216
    v_lshlrev_b32 v130, 16, v217
    v_and_b32 v131, 0xffff0000, v217
    v_lshlrev_b32 v132, 16, v218
    v_and_b32 v133, 0xffff0000, v218
    v_lshlrev_b32 v134, 16, v219
    v_and_b32 v135, 0xffff0000, v219
    s_mov_b32 s85, 2097152
L_py5_s:
    buffer_load_dwordx2 v[12:13], v233, s[40:43], 0 offen offset:1024 sc1
    s_sub_u32 s85, s85, 1
    s_cbranch_scc1 L_end
    s_waitcnt vmcnt(0)
    v_min_u32 v12, v12, v13
    v_cmp_le_u32 vcc, 1, v12
    s_cmp_eq_u64 vcc, exec
    s_cbranch_scc0 L_py5_s
    s_add_u32 m0, s99, 2048
    s_add_u32 s61, s95, 67584
    buffer_load_dwordx4 v64, s[16:19], s61 offen sc1 lds
    s_add_u32 m0, s99, 14336
    s_add_u32 s61, s95, 65536
    buffer_load_dwordx4 v64, s[16:19], s61 offen sc1 lds
    s_waitcnt vmcnt(0)
    ds_read_b128 v[80:83], v74 offset:0
    ds_read_b128 v[84:87], v74 offset:256
    ds_read_b128 v[88:91], v74 offset:12288
    ds_read_b128 v[92:95], v74 offset:12544
    s_waitcnt lgkmcnt(0)
    v_mfma_f32_16x16x32_bf16 v[96:99], v[80:83], v[32:35], 0
    v_mfma_f32_16x16x32_bf16 v[100:103], v[84:87], v[32:35], 0
    v_mfma_f32_16x16x32_bf16 v[104:107], v[88:91], v[32:35], 0
    v_mfma_f32_16x16x32_bf16 v[108:111], v[92:95], v[32:35], 0
    s_nop 5
    v_mul_f32 v96, v96, v120
    v_mul_f32 v97, v97, v121
    v_mul_f32 v98, v98, v122
    v_mul_f32 v99, v99, v123
    v_mul_f32 v100, v100, v124
    v_mul_f32 v101, v101, v125
    v_mul_f32 v102, v102, v126
    v_mul_f32 v103, v103, v127
    s_add_u32 s61, s93, 0
    v_cvt_pk_bf16_f32 v52, v96, v97
    v_cvt_pk_bf16_f32 v53, v98, v99
    v_cvt_pk_bf16_f32 v54, v100, v101
    v_cvt_pk_bf16_f32 v55, v102, v103
    buffer_store_dwordx4 v[52:55], v78, s[52:55], s61 offen nt
    v_mul_f32 v104, v104, v128
    v_mul_f32 v105, v105, v129
    v_mul_f32 v106, v106, v130
    v_mul_f32 v107, v107, v131
    v_mul_f32 v108, v108, v132
    v_mul_f32 v109, v109, v133
    v_mul_f32 v110, v110, v134
    v_mul_f32 v111, v111, v135
    s_add_u32 s61, s93, 2359296
    v_cvt_pk_bf16_f32 v56, v104, v105
    v_cvt_pk_bf16_f32 v57, v106, v107
    v_cvt_pk_bf16_f32 v58, v108, v109
    v_cvt_pk_bf16_f32 v59, v110, v111
    buffer_store_dwordx4 v[56:59], v78, s[52:55], s61 offen nt
L_np3x3_s:
    s_waitcnt vmcnt(2)
    s_cmp_eq_u32 s7, 3
    s_cbranch_scc1 L_q3_s
    s_waitcnt vmcnt(0)
L_q3_s:
    v_lshlrev_b32 v144, 16, v196
    v_and_b32 v145, 0xffff0000, v196
    v_lshlrev_b32 v146, 16, v197
    v_and_b32 v147, 0xffff0000, v197
    v_lshlrev_b32 v148, 16, v198
    v_and_b32 v149, 0xffff0000, v198
    v_lshlrev_b32 v150, 16, v199
    v_and_b32 v151, 0xffff0000, v199
    v_lshlrev_b32 v152, 16, v200
    v_and_b32 v153, 0xffff0000, v200
    v_lshlrev_b32 v154, 16, v201
    v_and_b32 v155, 0xffff0000, v201
    v_lshlrev_b32 v156, 16, v202
    v_and_b32 v157, 0xffff0000, v202
    v_lshlrev_b32 v158, 16, v203
    v_and_b32 v159, 0xffff0000, v203
    v_lshlrev_b32 v160, 16, v204
    v_and_b32 v161, 0xffff0000, v204
    v_lshlrev_b32 v162, 16, v205
    v_and_b32 v163, 0xffff0000, v205
    v_lshlrev_b32 v164, 16, v206
    v_and_b32 v165, 0xffff0000, v206
    v_lshlrev_b32 v166, 16, v207
    v_and_b32 v167, 0xffff0000, v207
    v_lshlrev_b32 v168, 16, v208
    v_and_b32 v169, 0xffff0000, v208
    v_lshlrev_b32 v170, 16, v209
    v_and_b32 v171, 0xffff0000, v209
    v_lshlrev_b32 v172, 16, v210
    v_and_b32 v173, 0xffff0000, v210
    v_lshlrev_b32 v174, 16, v211
    v_and_b32 v175, 0xffff0000, v211
    s_mov_b32 s85, 2097152
L_py_s:
    buffer_load_dwordx2 v[12:13], v233, s[40:43], 0 offen offset:512 sc1
    s_sub_u32 s85, s85, 1
    s_cbranch_scc1 L_end
    s_waitcnt vmcnt(0)
    v_min_u32 v12, v12, v13
    v_cmp_le_u32 vcc, 2, v12
    s_cmp_eq_u64 vcc, exec
    s_cbranch_scc0 L_py_s
    s_add_u32 m0, s99, 0
    s_sub_u32 s61, s87, 2359296
    buffer_load_dwordx4 v224, s[36:39], s61 offen sc1 lds
    s_add_u32 m0, s99, 1024
    s_sub_u32 s61, s88, 2359296
    buffer_load_dwordx4 v224, s[36:39], s61 offen sc1 lds
    s_add_u32 m0, s99, 12288
    s_sub_u32 s61, s87, 0
    buffer_load_dwordx4 v224, s[36:39], s61 offen sc1 lds
    s_add_u32 m0, s99, 13312
    s_sub_u32 s61, s88, 0
    buffer_load_dwordx4 v224, s[36:39], s61 offen sc1 lds
    s_waitcnt vmcnt(2)
    ds_read_b128 v[80:83], v73 offset:0
    ds_read_b128 v[84:87], v73 offset:256
    s_waitcnt vmcnt(0)
    ds_read_b128 v[88:91], v73 offset:12288
    ds_read_b128 v[92:95], v73 offset:12544
    s_waitcnt lgkmcnt(3)
    v_mfma_f32_16x16x32_bf16 v[96:99], v[80:83], v[28:31], 0
    s_waitcnt lgkmcnt(2)
    v_mfma_f32_16x16x32_bf16 v[100:103], v[84:87], v[28:31], 0
    v_mfma_f32_16x16x32_bf16 v[104:107], v[80:83], v[220:223], 0
    v_mfma_f32_16x16x32_bf16 v[108:111], v[84:87], v[220:223], 0
    s_waitcnt lgkmcnt(1)
    v_mfma_f32_16x16x32_bf16 v[112:115], v[88:91], v[28:31], 0
    s_waitcnt lgkmcnt(0)
    v_mfma_f32_16x16x32_bf16 v[116:119], v[92:95], v[28:31], 0
    v_mfma_f32_16x16x32_bf16 v[120:123], v[88:91], v[220:223], 0
    v_mfma_f32_16x16x32_bf16 v[124:127], v[92:95], v[220:223], 0
    s_nop 1
    v_pk_mul_f32 v[96:97], v[96:97], v[144:145]
    v_pk_mul_f32 v[98:99], v[98:99], v[146:147]
    v_pk_mul_f32 v[100:101], v[100:101], v[148:149]
    v_pk_mul_f32 v[102:103], v[102:103], v[150:151]
    s_add_u32 s61, s92, 0
    v_cvt_pk_bf16_f32 v36, v96, v97
    v_cvt_pk_bf16_f32 v37, v98, v99
    v_cvt_pk_bf16_f32 v38, v100, v101
    v_cvt_pk_bf16_f32 v39, v102, v103
    s_barrier
    buffer_store_dwordx4 v[36:39], v77, s[52:55], s61 offen
    v_pk_mul_f32 v[104:105], v[104:105], v[152:153]
    v_pk_mul_f32 v[106:107], v[106:107], v[154:155]
    v_pk_mul_f32 v[108:109], v[108:109], v[156:157]
    v_pk_mul_f32 v[110:111], v[110:111], v[158:159]
    s_add_u32 s61, s92, 9216
    v_cvt_pk_bf16_f32 v40, v104, v105
    v_cvt_pk_bf16_f32 v41, v106, v107
    v_cvt_pk_bf16_f32 v42, v108, v109
    v_cvt_pk_bf16_f32 v43, v110, v111
    buffer_store_dwordx4 v[40:43], v77, s[52:55], s61 offen
    v_pk_mul_f32 v[112:113], v[112:113], v[160:161]
    v_pk_mul_f32 v[114:115], v[114:115], v[162:163]
    v_pk_mul_f32 v[116:117], v[116:117], v[164:165]
    v_pk_mul_f32 v[118:119], v[118:119], v[166:167]
    s_add_u32 s61, s92, 2359296
    v_cvt_pk_bf16_f32 v44, v112, v113
    v_cvt_pk_bf16_f32 v45, v114, v115
    v_cvt_pk_bf16_f32 v46, v116, v117
    v_cvt_pk_bf16_f32 v47, v118, v119
    buffer_store_dwordx4 v[44:47], v77, s[52:55], s61 offen
    v_pk_mul_f32 v[120:121], v[120:121], v[168:169]
    v_pk_mul_f32 v[122:123], v[122:123], v[170:171]
    v_pk_mul_f32 v[124:125], v[124:125], v[172:173]
    v_pk_mul_f32 v[126:127], v[126:127], v[174:175]
    s_add_u32 s61, s92, 2368512
    v_cvt_pk_bf16_f32 v48, v120, v121
    v_cvt_pk_bf16_f32 v49, v122, v123
    v_cvt_pk_bf16_f32 v50, v124, v125
    v_cvt_pk_bf16_f32 v51, v126, v127
    buffer_store_dwordx4 v[48:51], v77, s[52:55], s61 offen
    s_endpgm
T_p1_s:
    s_setpc_b64 s[0:1]
L_p1_s:
    s_cmp_lt_u32 s7, 2
    s_cbranch_scc1 L_p1x_s
    ds_read_b128 v[80:83], v238 offset:14336
    ds_read_b128 v[84:87], v238 offset:12288
    ds_read_b128 v[88:91], v239 offset:14336
    ds_read_b128 v[92:95], v239 offset:12288
    s_waitcnt lgkmcnt(3)
    v_mfma_f32_16x16x32_bf16 v[104:107], v[80:83], v[24:27], 0
    s_waitcnt lgkmcnt(2)
    v_mfma_f32_16x16x32_bf16 v[108:111], v[84:87], v[24:27], 0
    s_waitcnt lgkmcnt(1)
    v_mfma_f32_16x16x32_bf16 v[112:115], v[88:91], v[24:27], 0
    s_waitcnt lgkmcnt(0)
    v_mfma_f32_16x16x32_bf16 v[116:119], v[92:95], v[24:27], 0
    s_nop 1
    v_mul_f32 v104, v104, v152
    v_mul_f32 v105, v105, v153
    v_mul_f32 v106, v106, v154
    v_mul_f32 v107, v107, v155
    v_cvt_pk_bf16_f32 v128, v104, v105
    v_cvt_pk_bf16_f32 v129, v106, v107
    v_mul_f32 v108, v108, v156
    v_mul_f32 v109, v109, v157
    v_mul_f32 v110, v110, v158
    v_mul_f32 v111, v111, v159
    v_cvt_pk_bf16_f32 v130, v108, v109
    v_cvt_pk_bf16_f32 v131, v110, v111
    ds_write_b128 v71, v[128:131] offset:0
    ds_read_b128 v[176:179], v72 offset:0
    v_mul_f32 v112, v112, v160
    v_mul_f32 v113, v113, v161
    v_mul_f32 v114, v114, v162
    v_mul_f32 v115, v115, v163
    v_cvt_pk_bf16_f32 v132, v112, v113
    v_cvt_pk_bf16_f32 v133, v114, v115
    v_mul_f32 v116, v116, v164
    v_mul_f32 v117, v117, v165
    v_mul_f32 v118, v118, v166
    v_mul_f32 v119, v119, v167
    v_cvt_pk_bf16_f32 v134, v116, v117
    v_cvt_pk_bf16_f32 v135, v118, v119
    ds_write_b128 v71, v[132:135] offset:1024
    ds_read_b128 v[180:183], v72 offset:1024
    s_waitcnt lgkmcnt(2)
    buffer_store_dwordx4 v[176:179], v224, s[36:39], s87 offen sc1
    s_waitcnt lgkmcnt(0)
    buffer_store_dwordx4 v[180:183], v224, s[36:39], s88 offen sc1
    s_setpc_b64 s[0:1]
T_p1x_s:
    s_setpc_b64 s[0:1]
L_p1x_s:
    ds_read_b128 v[80:83], v238 offset:14336
    ds_read_b128 v[84:87], v238 offset:12288
    ds_read_b128 v[88:91], v239 offset:14336
    ds_read_b128 v[92:95], v239 offset:12288
    ds_read_b128 v[96:99], v63 offset:256
    ds_read_b128 v[100:103], v63 offset:0
    ds_read_b128 v[188:191], v61 offset:320
    ds_read_b128 v[192:195], v61 offset:256
    ds_read_b128 v[196:199], v61 offset:64
    ds_read_b128 v[200:203], v61 offset:0
    s_waitcnt lgkmcnt(9)
    v_mfma_f32_16x16x32_bf16 v[104:107], v[80:83], v[24:27], 0
    s_waitcnt lgkmcnt(8)
    v_mfma_f32_16x16x32_bf16 v[108:111], v[84:87], v[24:27], 0
    s_waitcnt lgkmcnt(7)
    v_mfma_f32_16x16x32_bf16 v[112:115], v[88:91], v[24:27], 0
    s_waitcnt lgkmcnt(6)
    v_mfma_f32_16x16x32_bf16 v[116:119], v[92:95], v[24:27], 0
    s_waitcnt lgkmcnt(5)
    v_mfma_f32_16x16x32_bf16 v[120:123], v[96:99], v[24:27], 0
    s_waitcnt lgkmcnt(4)
    v_mfma_f32_16x16x32_bf16 v[124:127], v[100:103], v[24:27], 0
    s_waitcnt lgkmcnt(2)
    v_mfma_f32_16x16x32_bf16 v[168:171], v[188:191], v[52:55], 0
    v_mfma_f32_16x16x32_bf16 v[168:171], v[192:195], v[56:59], v[168:171]
    s_waitcnt lgkmcnt(0)
    v_mfma_f32_16x16x32_bf16 v[172:175], v[196:199], v[52:55], 0
    v_mfma_f32_16x16x32_bf16 v[172:175], v[200:203], v[56:59], v[172:175]
    v_mul_f32 v104, v104, v152
    v_mul_f32 v105, v105, v153
    v_mul_f32 v106, v106, v154
    v_mul_f32 v107, v107, v155
    v_cvt_pk_bf16_f32 v128, v104, v105
    v_cvt_pk_bf16_f32 v129, v106, v107
    v_mul_f32 v108, v108, v156
    v_mul_f32 v109, v109, v157
    v_mul_f32 v110, v110, v158
    v_mul_f32 v111, v111, v159
    v_cvt_pk_bf16_f32 v130, v108, v109
    v_cvt_pk_bf16_f32 v131, v110, v111
    ds_write_b128 v71, v[128:131] offset:0
    ds_read_b128 v[176:179], v72 offset:0
    v_mul_f32 v112, v112, v160
    v_mul_f32 v113, v113, v161
    v_mul_f32 v114, v114, v162
    v_mul_f32 v115, v115, v163
    v_cvt_pk_bf16_f32 v132, v112, v113
    v_cvt_pk_bf16_f32 v133, v114, v115
    v_mul_f32 v116, v116, v164
    v_mul_f32 v117, v117, v165
    v_mul_f32 v118, v118, v166
    v_mul_f32 v119, v119, v167
    v_cvt_pk_bf16_f32 v134, v116, v117
    v_cvt_pk_bf16_f32 v135, v118, v119
    ds_write_b128 v71, v[132:135] offset:1024
    ds_read_b128 v[180:183], v72 offset:1024
    s_waitcnt lgkmcnt(2)
    buffer_store_dwordx4 v[176:179], v224, s[36:39], s87 offen sc1
    v_mul_f32 v120, v120, v168
    v_mul_f32 v121, v121, v169
    v_mul_f32 v122, v122, v170
    v_mul_f32 v123, v123, v171
    v_cvt_pk_bf16_f32 v136, v120, v121
    v_cvt_pk_bf16_f32 v137, v122, v123
    v_mul_f32 v124, v124, v172
    v_mul_f32 v125, v125, v173
    v_mul_f32 v126, v126, v174
    v_mul_f32 v127, v127, v175
    v_cvt_pk_bf16_f32 v138, v124, v125
    v_cvt_pk_bf16_f32 v139, v126, v127
    ds_write_b128 v71, v[136:139] offset:0
    ds_read_b128 v[184:187], v72 offset:0
    s_waitcnt lgkmcnt(2)
    buffer_store_dwordx4 v[180:183], v224, s[36:39], s88 offen sc1
    s_waitcnt lgkmcnt(0)
    buffer_store_dwordx4 v[184:187], v64, s[16:19], s89 offen sc1
    s_setpc_b64 s[0:1]
L_Mslow:
    s_mul_i32 s38, s6, 1152
    s_add_u32 s38, s38, s56
    s_add_u32 s36, s38, 8388608
    s_add_u32 s36, s24, s36
    s_addc_u32 s37, s25, 0
    s_sub_u32 s38, 4718592, s38
    s_mov_b32 s39, 0x00020000
    s_lshl_b32 s48, s4, 17
    s_add_u32 s48, s48, 2097152
    s_add_u32 s48, s24, s48
    s_addc_u32 s49, s25, 0
    s_mov_b32 s50, 131072
    s_mov_b32 s51, 0x00020000
    s_lshl_b32 s40, s4, 11
    s_add_u32 s40, s40, 16842752
    s_add_u32 s40, s24, s40
    s_addc_u32 s41, s25, 0
    s_mov_b32 s42, 2048
    s_mov_b32 s43, 0x00020000
    s_waitcnt lgkmcnt(0)
    s_cmp_eq_u32 s100, 1
    s_cbranch_scc1 L_mv1_s
    s_cmp_eq_u32 s100, 2
    s_cbranch_scc1 L_mv2_s
    s_cmp_eq_u32 s100, 3
    s_cbranch_scc1 L_mv3_s
    s_branch L_mv0_s
L_mv0_s:
    v_mfma_f32_16x16x32_bf16 v[144:147], v[16:19], v[208:211], 0
    ds_read_b64_tr_b16 v[216:217], v3 offset:0
    v_mfma_f32_16x16x32_bf16 v[148:151], v[32:35], v[208:211], 0
    ds_read_b64_tr_b16 v[218:219], v3 offset:16
    v_mfma_f32_16x16x32_bf16 v[152:155], v[48:51], v[208:211], 0
    ds_read_b128 v[228:231], v242 offset:0
    v_mfma_f32_16x16x32_bf16 v[156:159], v[64:67], v[208:211], 0
    ds_read_b64_tr_b16 v[220:221], v3 offset:128
    v_mfma_f32_16x16x32_bf16 v[160:163], v[80:83], v[208:211], 0
    ds_read_b64_tr_b16 v[222:223], v3 offset:144
    v_mfma_f32_16x16x32_bf16 v[164:167], v[96:99], v[208:211], 0
    ds_read_b128 v[232:235], v243 offset:0
    v_mfma_f32_16x16x32_bf16 v[168:171], v[112:115], v[208:211], 0
    s_waitcnt lgkmcnt(3)
    ds_read_b64_tr_b16 v[224:225], v3 offset:256
    v_mfma_f32_16x16x32_bf16 v[12:15], v[216:219], v[228:231], 0
    ds_read_b64_tr_b16 v[226:227], v3 offset:272
    v_mfma_f32_16x16x32_bf16 v[172:175], v[128:131], v[208:211], 0
    ds_read_b128 v[236:239], v244 offset:0
    v_mfma_f32_16x16x32_bf16 v[176:179], v[16:19], v[212:215], 0
    ds_read_b128 v[208:211], v248 offset:14336
    v_mfma_f32_16x16x32_bf16 v[180:183], v[32:35], v[212:215], 0
    s_waitcnt lgkmcnt(4)
    ds_read_b64_tr_b16 v[216:217], v3 offset:384
    v_mfma_f32_16x16x32_bf16 v[12:15], v[220:223], v[232:235], v[12:15]
    ds_read_b64_tr_b16 v[218:219], v3 offset:400
    v_mfma_f32_16x16x32_bf16 v[184:187], v[48:51], v[212:215], 0
    ds_read_b128 v[228:231], v245 offset:0
    v_mfma_f32_16x16x32_bf16 v[188:191], v[64:67], v[212:215], 0
    ds_read_b64_tr_b16 v[220:221], v3 offset:512
    v_mfma_f32_16x16x32_bf16 v[192:195], v[80:83], v[212:215], 0
    ds_read_b64_tr_b16 v[222:223], v3 offset:528
    v_mfma_f32_16x16x32_bf16 v[196:199], v[96:99], v[212:215], 0
    s_waitcnt lgkmcnt(5)
    ds_read_b128 v[232:235], v242 offset:512
    v_mfma_f32_16x16x32_bf16 v[12:15], v[224:227], v[236:239], v[12:15]
    v_mfma_f32_16x16x32_bf16 v[200:203], v[112:115], v[212:215], 0
    ds_read_b64_tr_b16 v[224:225], v3 offset:640
    v_mfma_f32_16x16x32_bf16 v[204:207], v[128:131], v[212:215], 0
    ds_read_b128 v[212:215], v249 offset:14336
    v_mfma_f32_16x16x32_bf16 v[144:147], v[20:23], v[208:211], v[144:147]
    ds_read_b64_tr_b16 v[226:227], v3 offset:656
    v_mfma_f32_16x16x32_bf16 v[148:151], v[36:39], v[208:211], v[148:151]
    s_waitcnt lgkmcnt(4)
    ds_read_b128 v[236:239], v243 offset:512
    v_mfma_f32_16x16x32_bf16 v[12:15], v[216:219], v[228:231], v[12:15]
    ds_read_b64_tr_b16 v[216:217], v3 offset:768
    v_mfma_f32_16x16x32_bf16 v[152:155], v[52:55], v[208:211], v[152:155]
    ds_read_b64_tr_b16 v[218:219], v3 offset:784
    v_mfma_f32_16x16x32_bf16 v[156:159], v[68:71], v[208:211], v[156:159]
    ds_read_b128 v[228:231], v244 offset:512
    v_mfma_f32_16x16x32_bf16 v[160:163], v[84:87], v[208:211], v[160:163]
    v_mfma_f32_16x16x32_bf16 v[164:167], v[100:103], v[208:211], v[164:167]
    s_waitcnt lgkmcnt(4)
    v_mfma_f32_16x16x32_bf16 v[12:15], v[220:223], v[232:235], v[12:15]
    ds_read_b64_tr_b16 v[220:221], v3 offset:896
    v_mfma_f32_16x16x32_bf16 v[168:171], v[116:119], v[208:211], v[168:171]
    ds_read_b64_tr_b16 v[222:223], v3 offset:912
    v_mfma_f32_16x16x32_bf16 v[172:175], v[132:135], v[208:211], v[172:175]
    ds_read_b128 v[208:211], v250 offset:14336
    v_mfma_f32_16x16x32_bf16 v[176:179], v[20:23], v[212:215], v[176:179]
    ds_read_b128 v[232:235], v245 offset:512
    v_mfma_f32_16x16x32_bf16 v[180:183], v[36:39], v[212:215], v[180:183]
    s_waitcnt lgkmcnt(4)
    v_mfma_f32_16x16x32_bf16 v[12:15], v[224:227], v[236:239], v[12:15]
    ds_read_b64_tr_b16 v[224:225], v3 offset:1024
    v_mfma_f32_16x16x32_bf16 v[184:187], v[52:55], v[212:215], v[184:187]
    ds_read_b64_tr_b16 v[226:227], v3 offset:1040
    v_mfma_f32_16x16x32_bf16 v[188:191], v[68:71], v[212:215], v[188:191]
    ds_read_b128 v[236:239], v242 offset:1024
    v_mfma_f32_16x16x32_bf16 v[192:195], v[84:87], v[212:215], v[192:195]
    v_mfma_f32_16x16x32_bf16 v[12:15], v[216:219], v[228:231], v[12:15]
    v_mfma_f32_16x16x32_bf16 v[196:199], v[100:103], v[212:215], v[196:199]
    ds_read_b64_tr_b16 v[216:217], v3 offset:1152
    v_mfma_f32_16x16x32_bf16 v[200:203], v[116:119], v[212:215], v[200:203]
    ds_read_b64_tr_b16 v[218:219], v3 offset:1168
    v_mfma_f32_16x16x32_bf16 v[204:207], v[132:135], v[212:215], v[204:207]
    s_waitcnt lgkmcnt(3)
    ds_read_b128 v[212:215], v251 offset:14336
    v_mfma_f32_16x16x32_bf16 v[144:147], v[24:27], v[208:211], v[144:147]
    ds_read_b128 v[228:231], v243 offset:1024
    v_mfma_f32_16x16x32_bf16 v[12:15], v[220:223], v[232:235], v[12:15]
    v_mfma_f32_16x16x32_bf16 v[148:151], v[40:43], v[208:211], v[148:151]
    ds_read_b64_tr_b16 v[220:221], v3 offset:1280
    v_mfma_f32_16x16x32_bf16 v[152:155], v[56:59], v[208:211], v[152:155]
    ds_read_b64_tr_b16 v[222:223], v3 offset:1296
    v_mfma_f32_16x16x32_bf16 v[156:159], v[72:75], v[208:211], v[156:159]
    ds_read_b128 v[232:235], v244 offset:1024
    v_mfma_f32_16x16x32_bf16 v[160:163], v[88:91], v[208:211], v[160:163]
    s_waitcnt lgkmcnt(4)
    v_mfma_f32_16x16x32_bf16 v[12:15], v[224:227], v[236:239], v[12:15]
    v_mfma_f32_16x16x32_bf16 v[164:167], v[104:107], v[208:211], v[164:167]
    ds_read_b64_tr_b16 v[224:225], v3 offset:1408
    v_mfma_f32_16x16x32_bf16 v[168:171], v[120:123], v[208:211], v[168:171]
    ds_read_b64_tr_b16 v[226:227], v3 offset:1424
    v_mfma_f32_16x16x32_bf16 v[172:175], v[136:139], v[208:211], v[172:175]
    ds_read_b128 v[208:211], v252 offset:14336
    v_mfma_f32_16x16x32_bf16 v[176:179], v[24:27], v[212:215], v[176:179]
    s_waitcnt lgkmcnt(3)
    ds_read_b128 v[236:239], v245 offset:1024
    v_mfma_f32_16x16x32_bf16 v[12:15], v[216:219], v[228:231], v[12:15]
    ds_read_b64_tr_b16 v[216:217], v3 offset:1536
    v_mfma_f32_16x16x32_bf16 v[180:183], v[40:43], v[212:215], v[180:183]
    ds_read_b64_tr_b16 v[218:219], v3 offset:1552
    v_mfma_f32_16x16x32_bf16 v[184:187], v[56:59], v[212:215], v[184:187]
    ds_read_b128 v[228:231], v242 offset:1536
    v_mfma_f32_16x16x32_bf16 v[188:191], v[72:75], v[212:215], v[188:191]
    v_mfma_f32_16x16x32_bf16 v[192:195], v[88:91], v[212:215], v[192:195]
    v_mfma_f32_16x16x32_bf16 v[12:15], v[220:223], v[232:235], v[12:15]
    ds_read_b64_tr_b16 v[220:221], v3 offset:1664
    v_mfma_f32_16x16x32_bf16 v[196:199], v[104:107], v[212:215], v[196:199]
    ds_read_b64_tr_b16 v[222:223], v3 offset:1680
    v_mfma_f32_16x16x32_bf16 v[200:203], v[120:123], v[212:215], v[200:203]
    ds_read_b128 v[232:235], v243 offset:1536
    v_mfma_f32_16x16x32_bf16 v[204:207], v[136:139], v[212:215], v[204:207]
    s_waitcnt lgkmcnt(3)
    ds_read_b128 v[212:215], v253 offset:14336
    v_mfma_f32_16x16x32_bf16 v[144:147], v[28:31], v[208:211], v[144:147]
    v_mfma_f32_16x16x32_bf16 v[12:15], v[224:227], v[236:239], v[12:15]
    ds_read_b64_tr_b16 v[224:225], v3 offset:1792
    v_mfma_f32_16x16x32_bf16 v[148:151], v[44:47], v[208:211], v[148:151]
    ds_read_b64_tr_b16 v[226:227], v3 offset:1808
    v_mfma_f32_16x16x32_bf16 v[152:155], v[60:63], v[208:211], v[152:155]
    ds_read_b128 v[236:239], v244 offset:1536
    v_mfma_f32_16x16x32_bf16 v[156:159], v[76:79], v[208:211], v[156:159]
    v_mfma_f32_16x16x32_bf16 v[12:15], v[216:219], v[228:231], v[12:15]
    v_mfma_f32_16x16x32_bf16 v[160:163], v[92:95], v[208:211], v[160:163]
    ds_read_b64_tr_b16 v[216:217], v3 offset:1920
    v_mfma_f32_16x16x32_bf16 v[164:167], v[108:111], v[208:211], v[164:167]
    ds_read_b64_tr_b16 v[218:219], v3 offset:1936
    v_mfma_f32_16x16x32_bf16 v[168:171], v[124:127], v[208:211], v[168:171]
    ds_read_b128 v[228:231], v245 offset:1536
    v_mfma_f32_16x16x32_bf16 v[172:175], v[140:143], v[208:211], v[172:175]
    s_waitcnt lgkmcnt(3)
    ds_read_b128 v[208:211], v246 offset:12288
    v_mfma_f32_16x16x32_bf16 v[12:15], v[220:223], v[232:235], v[12:15]
    v_mfma_f32_16x16x32_bf16 v[176:179], v[28:31], v[212:215], v[176:179]
    ds_read_b64_tr_b16 v[220:221], v3 offset:2048
    v_mfma_f32_16x16x32_bf16 v[180:183], v[44:47], v[212:215], v[180:183]
    ds_read_b64_tr_b16 v[222:223], v3 offset:2064
    v_mfma_f32_16x16x32_bf16 v[184:187], v[60:63], v[212:215], v[184:187]
    ds_read_b128 v[232:235], v242 offset:2048
    v_mfma_f32_16x16x32_bf16 v[188:191], v[76:79], v[212:215], v[188:191]
    v_mfma_f32_16x16x32_bf16 v[12:15], v[224:227], v[236:239], v[12:15]
    v_mfma_f32_16x16x32_bf16 v[192:195], v[92:95], v[212:215], v[192:195]
    ds_read_b64_tr_b16 v[224:225], v3 offset:2176
    v_bfi_b32 v240, v5, 0, v179
    v_mfma_f32_16x16x32_bf16 v[196:199], v[108:111], v[212:215], v[196:199]
    ds_bpermute_b32 v240, v4, v240
    v_add_f32 v146, v146, v177
    v_mfma_f32_16x16x32_bf16 v[200:203], v[124:127], v[212:215], v[200:203]
    ds_read_b64_tr_b16 v[226:227], v3 offset:2192
    v_add_f32 v147, v147, v178
    v_mfma_f32_16x16x32_bf16 v[204:207], v[140:143], v[212:215], v[204:207]
    s_waitcnt lgkmcnt(3)
    ds_read_b128 v[212:215], v247 offset:12288
    v_add_f32 v145, v145, v176
    v_mfma_f32_16x16x32_bf16 v[12:15], v[216:219], v[228:231], v[12:15]
    ds_read_b128 v[236:239], v243 offset:2048
    v_cvt_pk_bf16_f32 v9, v146, v147
    v_mfma_f32_16x16x32_bf16 v[148:151], v[16:19], v[208:211], v[148:151]
    ds_read_b64_tr_b16 v[216:217], v3 offset:2304
    v_mfma_f32_16x16x32_bf16 v[152:155], v[32:35], v[208:211], v[152:155]
    s_waitcnt lgkmcnt(4)
    ds_read_b64_tr_b16 v[218:219], v3 offset:2320
    v_add_f32 v144, v144, v240
    v_mfma_f32_16x16x32_bf16 v[156:159], v[48:51], v[208:211], v[156:159]
    ds_read_b128 v[228:231], v244 offset:2048
    v_cvt_pk_bf16_f32 v8, v144, v145
    v_mfma_f32_16x16x32_bf16 v[160:163], v[64:67], v[208:211], v[160:163]
    v_mfma_f32_16x16x32_bf16 v[12:15], v[220:223], v[232:235], v[12:15]
    ds_read_b64_tr_b16 v[220:221], v3 offset:2432
    v_mfma_f32_16x16x32_bf16 v[164:167], v[80:83], v[208:211], v[164:167]
    ds_read_b64_tr_b16 v[222:223], v3 offset:2448
    v_mfma_f32_16x16x32_bf16 v[168:171], v[96:99], v[208:211], v[168:171]
    ds_read_b128 v[232:235], v245 offset:2048
    v_mfma_f32_16x16x32_bf16 v[172:175], v[112:115], v[208:211], v[172:175]
    s_waitcnt lgkmcnt(4)
    ds_read_b128 v[208:211], v248 offset:12288
    v_mfma_f32_16x16x32_bf16 v[180:183], v[16:19], v[212:215], v[180:183]
    v_mfma_f32_16x16x32_bf16 v[12:15], v[224:227], v[236:239], v[12:15]
    ds_read_b64_tr_b16 v[224:225], v3 offset:2560
    v_mfma_f32_16x16x32_bf16 v[184:187], v[32:35], v[212:215], v[184:187]
    ds_read_b64_tr_b16 v[226:227], v3 offset:2576
    v_mfma_f32_16x16x32_bf16 v[188:191], v[48:51], v[212:215], v[188:191]
    ds_read_b128 v[236:239], v242 offset:2560
    v_mfma_f32_16x16x32_bf16 v[192:195], v[64:67], v[212:215], v[192:195]
    s_waitcnt lgkmcnt(4)
    v_mfma_f32_16x16x32_bf16 v[12:15], v[216:219], v[228:231], v[12:15]
    v_mfma_f32_16x16x32_bf16 v[196:199], v[80:83], v[212:215], v[196:199]
    ds_read_b64_tr_b16 v[216:217], v3 offset:2688
    v_mfma_f32_16x16x32_bf16 v[200:203], v[96:99], v[212:215], v[200:203]
    ds_read_b64_tr_b16 v[218:219], v3 offset:2704
    v_mfma_f32_16x16x32_bf16 v[204:207], v[112:115], v[212:215], v[204:207]
    s_waitcnt lgkmcnt(3)
    ds_read_b128 v[212:215], v249 offset:12288
    v_mfma_f32_16x16x32_bf16 v[148:151], v[20:23], v[208:211], v[148:151]
    ds_read_b128 v[228:231], v243 offset:2560
    v_mfma_f32_16x16x32_bf16 v[12:15], v[220:223], v[232:235], v[12:15]
    v_mfma_f32_16x16x32_bf16 v[152:155], v[36:39], v[208:211], v[152:155]
    ds_read_b64_tr_b16 v[220:221], v3 offset:2816
    v_mfma_f32_16x16x32_bf16 v[156:159], v[52:55], v[208:211], v[156:159]
    ds_read_b64_tr_b16 v[222:223], v3 offset:2832
    v_mfma_f32_16x16x32_bf16 v[160:163], v[68:71], v[208:211], v[160:163]
    ds_read_b128 v[232:235], v244 offset:2560
    v_mfma_f32_16x16x32_bf16 v[164:167], v[84:87], v[208:211], v[164:167]
    s_waitcnt lgkmcnt(4)
    v_mfma_f32_16x16x32_bf16 v[12:15], v[224:227], v[236:239], v[12:15]
    v_mfma_f32_16x16x32_bf16 v[168:171], v[100:103], v[208:211], v[168:171]
    ds_read_b64_tr_b16 v[224:225], v3 offset:2944
    v_mfma_f32_16x16x32_bf16 v[172:175], v[116:119], v[208:211], v[172:175]
    ds_read_b128 v[208:211], v250 offset:12288
    v_mfma_f32_16x16x32_bf16 v[180:183], v[20:23], v[212:215], v[180:183]
    ds_read_b64_tr_b16 v[226:227], v3 offset:2960
    v_mfma_f32_16x16x32_bf16 v[184:187], v[36:39], v[212:215], v[184:187]
    s_waitcnt lgkmcnt(3)
    ds_read_b128 v[236:239], v245 offset:2560
    v_mfma_f32_16x16x32_bf16 v[12:15], v[216:219], v[228:231], v[12:15]
    ds_read_b64_tr_b16 v[216:217], v3 offset:3072
    v_mfma_f32_16x16x32_bf16 v[188:191], v[52:55], v[212:215], v[188:191]
    ds_read_b64_tr_b16 v[218:219], v3 offset:3088
    v_mfma_f32_16x16x32_bf16 v[192:195], v[68:71], v[212:215], v[192:195]
    ds_read_b128 v[228:231], v242 offset:3072
    v_mfma_f32_16x16x32_bf16 v[196:199], v[84:87], v[212:215], v[196:199]
    v_mfma_f32_16x16x32_bf16 v[200:203], v[100:103], v[212:215], v[200:203]
    v_mfma_f32_16x16x32_bf16 v[12:15], v[220:223], v[232:235], v[12:15]
    ds_read_b64_tr_b16 v[220:221], v3 offset:3200
    v_mfma_f32_16x16x32_bf16 v[204:207], v[116:119], v[212:215], v[204:207]
    s_waitcnt lgkmcnt(3)
    ds_read_b128 v[212:215], v251 offset:12288
    v_mfma_f32_16x16x32_bf16 v[148:151], v[24:27], v[208:211], v[148:151]
    ds_read_b64_tr_b16 v[222:223], v3 offset:3216
    v_mfma_f32_16x16x32_bf16 v[152:155], v[40:43], v[208:211], v[152:155]
    ds_read_b128 v[232:235], v243 offset:3072
    v_mfma_f32_16x16x32_bf16 v[156:159], v[56:59], v[208:211], v[156:159]
    v_mfma_f32_16x16x32_bf16 v[12:15], v[224:227], v[236:239], v[12:15]
    ds_read_b64_tr_b16 v[224:225], v3 offset:3328
    v_mfma_f32_16x16x32_bf16 v[160:163], v[72:75], v[208:211], v[160:163]
    ds_read_b64_tr_b16 v[226:227], v3 offset:3344
    v_mfma_f32_16x16x32_bf16 v[164:167], v[88:91], v[208:211], v[164:167]
    ds_read_b128 v[236:239], v244 offset:3072
    v_mfma_f32_16x16x32_bf16 v[168:171], v[104:107], v[208:211], v[168:171]
    s_waitcnt lgkmcnt(4)
    v_mfma_f32_16x16x32_bf16 v[12:15], v[216:219], v[228:231], v[12:15]
    v_mfma_f32_16x16x32_bf16 v[172:175], v[120:123], v[208:211], v[172:175]
    ds_read_b128 v[208:211], v252 offset:12288
    v_mfma_f32_16x16x32_bf16 v[180:183], v[24:27], v[212:215], v[180:183]
    ds_read_b64_tr_b16 v[216:217], v3 offset:3456
    v_mfma_f32_16x16x32_bf16 v[184:187], v[40:43], v[212:215], v[184:187]
    ds_read_b64_tr_b16 v[218:219], v3 offset:3472
    v_mfma_f32_16x16x32_bf16 v[188:191], v[56:59], v[212:215], v[188:191]
    s_waitcnt lgkmcnt(3)
    ds_read_b128 v[228:231], v245 offset:3072
    v_mfma_f32_16x16x32_bf16 v[12:15], v[220:223], v[232:235], v[12:15]
    v_mfma_f32_16x16x32_bf16 v[192:195], v[72:75], v[212:215], v[192:195]
    ds_read_b64_tr_b16 v[220:221], v3 offset:3584
    v_mfma_f32_16x16x32_bf16 v[196:199], v[88:91], v[212:215], v[196:199]
    ds_read_b64_tr_b16 v[222:223], v3 offset:3600
    v_mfma_f32_16x16x32_bf16 v[200:203], v[104:107], v[212:215], v[200:203]
    ds_read_b128 v[232:235], v242 offset:3584
    v_mfma_f32_16x16x32_bf16 v[204:207], v[120:123], v[212:215], v[204:207]
    ds_read_b128 v[212:215], v253 offset:12288
    v_mfma_f32_16x16x32_bf16 v[12:15], v[224:227], v[236:239], v[12:15]
    s_waitcnt lgkmcnt(4)
    v_mfma_f32_16x16x32_bf16 v[148:151], v[28:31], v[208:211], v[148:151]
    ds_read_b64_tr_b16 v[224:225], v3 offset:3712
    v_mfma_f32_16x16x32_bf16 v[152:155], v[44:47], v[208:211], v[152:155]
    ds_read_b64_tr_b16 v[226:227], v3 offset:3728
    v_mfma_f32_16x16x32_bf16 v[156:159], v[60:63], v[208:211], v[156:159]
    ds_read_b128 v[236:239], v243 offset:3584
    v_mfma_f32_16x16x32_bf16 v[160:163], v[76:79], v[208:211], v[160:163]
    v_mfma_f32_16x16x32_bf16 v[12:15], v[216:219], v[228:231], v[12:15]
    ds_read_b64_tr_b16 v[216:217], v3 offset:3840
    v_mfma_f32_16x16x32_bf16 v[164:167], v[92:95], v[208:211], v[164:167]
    ds_read_b64_tr_b16 v[218:219], v3 offset:3856
    v_mfma_f32_16x16x32_bf16 v[168:171], v[108:111], v[208:211], v[168:171]
    ds_read_b128 v[228:231], v244 offset:3584
    v_mfma_f32_16x16x32_bf16 v[172:175], v[124:127], v[208:211], v[172:175]
    s_waitcnt lgkmcnt(4)
    ds_read_b128 v[208:211], v246 offset:10240
    v_mfma_f32_16x16x32_bf16 v[180:183], v[28:31], v[212:215], v[180:183]
    v_mfma_f32_16x16x32_bf16 v[12:15], v[220:223], v[232:235], v[12:15]
    ds_read_b64_tr_b16 v[220:221], v3 offset:3968
    v_mfma_f32_16x16x32_bf16 v[184:187], v[44:47], v[212:215], v[184:187]
    ds_read_b64_tr_b16 v[222:223], v3 offset:3984
    v_mfma_f32_16x16x32_bf16 v[188:191], v[60:63], v[212:215], v[188:191]
    ds_read_b128 v[232:235], v245 offset:3584
    v_mfma_f32_16x16x32_bf16 v[192:195], v[76:79], v[212:215], v[192:195]
    v_mfma_f32_16x16x32_bf16 v[196:199], v[92:95], v[212:215], v[196:199]
    s_waitcnt lgkmcnt(3)
    v_bfi_b32 v241, v5, v179, v183
    v_add_f32 v150, v150, v181
    v_mfma_f32_16x16x32_bf16 v[12:15], v[224:227], v[236:239], v[12:15]
    ds_bpermute_b32 v241, v4, v241
    v_add_f32 v151, v151, v182
    v_mfma_f32_16x16x32_bf16 v[200:203], v[108:111], v[212:215], v[200:203]
    ds_read_b64_tr_b16 v[224:225], v3 offset:0
    v_add_f32 v149, v149, v180
    v_mfma_f32_16x16x32_bf16 v[204:207], v[124:127], v[212:215], v[204:207]
    ds_read_b128 v[212:215], v247 offset:10240
    v_cvt_pk_bf16_f32 v11, v150, v151
    v_mfma_f32_16x16x32_bf16 v[152:155], v[16:19], v[208:211], v[152:155]
    ds_read_b64_tr_b16 v[226:227], v3 offset:16
    v_mfma_f32_16x16x32_bf16 v[12:15], v[216:219], v[228:231], v[12:15]
    ds_read_b128 v[236:239], v242 offset:3584
    v_mfma_f32_16x16x32_bf16 v[156:159], v[32:35], v[208:211], v[156:159]
    s_waitcnt lgkmcnt(4)
    ds_read_b64_tr_b16 v[216:217], v3 offset:128
    v_add_f32 v148, v148, v241
    v_mfma_f32_16x16x32_bf16 v[160:163], v[48:51], v[208:211], v[160:163]
    ds_read_b64_tr_b16 v[218:219], v3 offset:144
    v_cvt_pk_bf16_f32 v10, v148, v149
    v_mfma_f32_16x16x32_bf16 v[164:167], v[64:67], v[208:211], v[164:167]
    ds_read_b128 v[228:231], v243 offset:3584
    v_permlane16_swap_b32 v9, v11
    v_mfma_f32_16x16x32_bf16 v[168:171], v[80:83], v[208:211], v[168:171]
    v_mfma_f32_16x16x32_bf16 v[12:15], v[220:223], v[232:235], v[12:15]
    v_permlane16_swap_b32 v8, v10
    v_mfma_f32_16x16x32_bf16 v[172:175], v[96:99], v[208:211], v[172:175]
    s_waitcnt lgkmcnt(3)
    buffer_store_dwordx4 v[8:11], v6, s[36:39], s52 offen sc1
    v_mfma_f32_16x16x32_bf16 v[184:187], v[16:19], v[212:215], v[184:187]
    ds_read_b128 v[208:211], v248 offset:10240
    v_mfma_f32_16x16x32_bf16 v[188:191], v[32:35], v[212:215], v[188:191]
    ds_read_b64_tr_b16 v[220:221], v3 offset:256
    v_mfma_f32_16x16x32_bf16 v[192:195], v[48:51], v[212:215], v[192:195]
    ds_read_b64_tr_b16 v[222:223], v3 offset:272
    v_mfma_f32_16x16x32_bf16 v[140:143], v[224:227], v[236:239], 0
    ds_read_b128 v[232:235], v244 offset:3584
    v_mfma_f32_16x16x32_bf16 v[196:199], v[64:67], v[212:215], v[196:199]
    ds_read_b64_tr_b16 v[224:225], v3 offset:384
    v_mfma_f32_16x16x32_bf16 v[200:203], v[80:83], v[212:215], v[200:203]
    ds_read_b64_tr_b16 v[226:227], v3 offset:400
    s_branch L_mt_s
L_mv1_s:
    v_mfma_f32_16x16x32_bf16 v[144:147], v[16:19], v[208:211], 0
    ds_read_b64_tr_b16 v[216:217], v3 offset:0
    v_mfma_f32_16x16x32_bf16 v[148:151], v[32:35], v[208:211], 0
    ds_read_b64_tr_b16 v[218:219], v3 offset:16
    v_mfma_f32_16x16x32_bf16 v[152:155], v[48:51], v[208:211], 0
    ds_read_b128 v[228:231], v242 offset:512
    v_mfma_f32_16x16x32_bf16 v[156:159], v[64:67], v[208:211], 0
    ds_read_b64_tr_b16 v[220:221], v3 offset:128
    v_mfma_f32_16x16x32_bf16 v[160:163], v[80:83], v[208:211], 0
    ds_read_b64_tr_b16 v[222:223], v3 offset:144
    v_mfma_f32_16x16x32_bf16 v[164:167], v[96:99], v[208:211], 0
    ds_read_b128 v[232:235], v243 offset:512
    v_mfma_f32_16x16x32_bf16 v[168:171], v[112:115], v[208:211], 0
    s_waitcnt lgkmcnt(3)
    ds_read_b64_tr_b16 v[224:225], v3 offset:256
    v_mfma_f32_16x16x32_bf16 v[12:15], v[216:219], v[228:231], 0
    ds_read_b64_tr_b16 v[226:227], v3 offset:272
    v_mfma_f32_16x16x32_bf16 v[172:175], v[128:131], v[208:211], 0
    ds_read_b128 v[236:239], v244 offset:512
    v_mfma_f32_16x16x32_bf16 v[176:179], v[16:19], v[212:215], 0
    ds_read_b128 v[208:211], v248 offset:14336
    v_mfma_f32_16x16x32_bf16 v[180:183], v[32:35], v[212:215], 0
    s_waitcnt lgkmcnt(4)
    ds_read_b64_tr_b16 v[216:217], v3 offset:384
    v_mfma_f32_16x16x32_bf16 v[12:15], v[220:223], v[232:235], v[12:15]
    ds_read_b64_tr_b16 v[218:219], v3 offset:400
    v_mfma_f32_16x16x32_bf16 v[184:187], v[48:51], v[212:215], 0
    ds_read_b128 v[228:231], v245 offset:512
    v_mfma_f32_16x16x32_bf16 v[188:191], v[64:67], v[212:215], 0
    ds_read_b64_tr_b16 v[220:221], v3 offset:512
    v_mfma_f32_16x16x32_bf16 v[192:195], v[80:83], v[212:215], 0
    ds_read_b64_tr_b16 v[222:223], v3 offset:528
    v_mfma_f32_16x16x32_bf16 v[196:199], v[96:99], v[212:215], 0
    s_waitcnt lgkmcnt(5)
    ds_read_b128 v[232:235], v242 offset:1024
    v_mfma_f32_16x16x32_bf16 v[12:15], v[224:227], v[236:239], v[12:15]
    v_mfma_f32_16x16x32_bf16 v[200:203], v[112:115], v[212:215], 0
    ds_read_b64_tr_b16 v[224:225], v3 offset:640
    v_mfma_f32_16x16x32_bf16 v[204:207], v[128:131], v[212:215], 0
    ds_read_b128 v[212:215], v249 offset:14336
    v_mfma_f32_16x16x32_bf16 v[144:147], v[20:23], v[208:211], v[144:147]
    ds_read_b64_tr_b16 v[226:227], v3 offset:656
    v_mfma_f32_16x16x32_bf16 v[148:151], v[36:39], v[208:211], v[148:151]
    s_waitcnt lgkmcnt(4)
    ds_read_b128 v[236:239], v243 offset:1024
    v_mfma_f32_16x16x32_bf16 v[12:15], v[216:219], v[228:231], v[12:15]
    ds_read_b64_tr_b16 v[216:217], v3 offset:768
    v_mfma_f32_16x16x32_bf16 v[152:155], v[52:55], v[208:211], v[152:155]
    ds_read_b64_tr_b16 v[218:219], v3 offset:784
    v_mfma_f32_16x16x32_bf16 v[156:159], v[68:71], v[208:211], v[156:159]
    ds_read_b128 v[228:231], v244 offset:1024
    v_mfma_f32_16x16x32_bf16 v[160:163], v[84:87], v[208:211], v[160:163]
    v_mfma_f32_16x16x32_bf16 v[164:167], v[100:103], v[208:211], v[164:167]
    s_waitcnt lgkmcnt(4)
    v_mfma_f32_16x16x32_bf16 v[12:15], v[220:223], v[232:235], v[12:15]
    ds_read_b64_tr_b16 v[220:221], v3 offset:896
    v_mfma_f32_16x16x32_bf16 v[168:171], v[116:119], v[208:211], v[168:171]
    ds_read_b64_tr_b16 v[222:223], v3 offset:912
    v_mfma_f32_16x16x32_bf16 v[172:175], v[132:135], v[208:211], v[172:175]
    ds_read_b128 v[208:211], v250 offset:14336
    v_mfma_f32_16x16x32_bf16 v[176:179], v[20:23], v[212:215], v[176:179]
    ds_read_b128 v[232:235], v245 offset:1024
    v_mfma_f32_16x16x32_bf16 v[180:183], v[36:39], v[212:215], v[180:183]
    s_waitcnt lgkmcnt(4)
    v_mfma_f32_16x16x32_bf16 v[12:15], v[224:227], v[236:239], v[12:15]
    ds_read_b64_tr_b16 v[224:225], v3 offset:1024
    v_mfma_f32_16x16x32_bf16 v[184:187], v[52:55], v[212:215], v[184:187]
    ds_read_b64_tr_b16 v[226:227], v3 offset:1040
    v_mfma_f32_16x16x32_bf16 v[188:191], v[68:71], v[212:215], v[188:191]
    ds_read_b128 v[236:239], v242 offset:1536
    v_mfma_f32_16x16x32_bf16 v[192:195], v[84:87], v[212:215], v[192:195]
    v_mfma_f32_16x16x32_bf16 v[12:15], v[216:219], v[228:231], v[12:15]
    v_mfma_f32_16x16x32_bf16 v[196:199], v[100:103], v[212:215], v[196:199]
    ds_read_b64_tr_b16 v[216:217], v3 offset:1152
    v_mfma_f32_16x16x32_bf16 v[200:203], v[116:119], v[212:215], v[200:203]
    ds_read_b64_tr_b16 v[218:219], v3 offset:1168
    v_mfma_f32_16x16x32_bf16 v[204:207], v[132:135], v[212:215], v[204:207]
    s_waitcnt lgkmcnt(3)
    ds_read_b128 v[212:215], v251 offset:14336
    v_mfma_f32_16x16x32_bf16 v[144:147], v[24:27], v[208:211], v[144:147]
    ds_read_b128 v[228:231], v243 offset:1536
    v_mfma_f32_16x16x32_bf16 v[12:15], v[220:223], v[232:235], v[12:15]
    v_mfma_f32_16x16x32_bf16 v[148:151], v[40:43], v[208:211], v[148:151]
    ds_read_b64_tr_b16 v[220:221], v3 offset:1280
    v_mfma_f32_16x16x32_bf16 v[152:155], v[56:59], v[208:211], v[152:155]
    ds_read_b64_tr_b16 v[222:223], v3 offset:1296
    v_mfma_f32_16x16x32_bf16 v[156:159], v[72:75], v[208:211], v[156:159]
    ds_read_b128 v[232:235], v244 offset:1536
    v_mfma_f32_16x16x32_bf16 v[160:163], v[88:91], v[208:211], v[160:163]
    s_waitcnt lgkmcnt(4)
    v_mfma_f32_16x16x32_bf16 v[12:15], v[224:227], v[236:239], v[12:15]
    v_mfma_f32_16x16x32_bf16 v[164:167], v[104:107], v[208:211], v[164:167]
    ds_read_b64_tr_b16 v[224:225], v3 offset:1408
    v_mfma_f32_16x16x32_bf16 v[168:171], v[120:123], v[208:211], v[168:171]
    ds_read_b64_tr_b16 v[226:227], v3 offset:1424
    v_mfma_f32_16x16x32_bf16 v[172:175], v[136:139], v[208:211], v[172:175]
    ds_read_b128 v[208:211], v252 offset:14336
    v_mfma_f32_16x16x32_bf16 v[176:179], v[24:27], v[212:215], v[176:179]
    s_waitcnt lgkmcnt(3)
    ds_read_b128 v[236:239], v245 offset:1536
    v_mfma_f32_16x16x32_bf16 v[12:15], v[216:219], v[228:231], v[12:15]
    ds_read_b64_tr_b16 v[216:217], v3 offset:1536
    v_mfma_f32_16x16x32_bf16 v[180:183], v[40:43], v[212:215], v[180:183]
    ds_read_b64_tr_b16 v[218:219], v3 offset:1552
    v_mfma_f32_16x16x32_bf16 v[184:187], v[56:59], v[212:215], v[184:187]
    ds_read_b128 v[228:231], v242 offset:2048
    v_mfma_f32_16x16x32_bf16 v[188:191], v[72:75], v[212:215], v[188:191]
    v_mfma_f32_16x16x32_bf16 v[192:195], v[88:91], v[212:215], v[192:195]
    v_mfma_f32_16x16x32_bf16 v[12:15], v[220:223], v[232:235], v[12:15]
    ds_read_b64_tr_b16 v[220:221], v3 offset:1664
    v_mfma_f32_16x16x32_bf16 v[196:199], v[104:107], v[212:215], v[196:199]
    ds_read_b64_tr_b16 v[222:223], v3 offset:1680
    v_mfma_f32_16x16x32_bf16 v[200:203], v[120:123], v[212:215], v[200:203]
    ds_read_b128 v[232:235], v243 offset:2048
    v_mfma_f32_16x16x32_bf16 v[204:207], v[136:139], v[212:215], v[204:207]
    s_waitcnt lgkmcnt(3)
    ds_read_b128 v[212:215], v253 offset:14336
    v_mfma_f32_16x16x32_bf16 v[144:147], v[28:31], v[208:211], v[144:147]
    v_mfma_f32_16x16x32_bf16 v[12:15], v[224:227], v[236:239], v[12:15]
    ds_read_b64_tr_b16 v[224:225], v3 offset:1792
    v_mfma_f32_16x16x32_bf16 v[148:151], v[44:47], v[208:211], v[148:151]
    ds_read_b64_tr_b16 v[226:227], v3 offset:1808
    v_mfma_f32_16x16x32_bf16 v[152:155], v[60:63], v[208:211], v[152:155]
    ds_read_b128 v[236:239], v244 offset:2048
    v_mfma_f32_16x16x32_bf16 v[156:159], v[76:79], v[208:211], v[156:159]
    v_mfma_f32_16x16x32_bf16 v[12:15], v[216:219], v[228:231], v[12:15]
    v_mfma_f32_16x16x32_bf16 v[160:163], v[92:95], v[208:211], v[160:163]
    ds_read_b64_tr_b16 v[216:217], v3 offset:1920
    v_mfma_f32_16x16x32_bf16 v[164:167], v[108:111], v[208:211], v[164:167]
    ds_read_b64_tr_b16 v[218:219], v3 offset:1936
    v_mfma_f32_16x16x32_bf16 v[168:171], v[124:127], v[208:211], v[168:171]
    ds_read_b128 v[228:231], v245 offset:2048
    v_mfma_f32_16x16x32_bf16 v[172:175], v[140:143], v[208:211], v[172:175]
    s_waitcnt lgkmcnt(3)
    ds_read_b128 v[208:211], v246 offset:12288
    v_mfma_f32_16x16x32_bf16 v[12:15], v[220:223], v[232:235], v[12:15]
    v_mfma_f32_16x16x32_bf16 v[176:179], v[28:31], v[212:215], v[176:179]
    ds_read_b64_tr_b16 v[220:221], v3 offset:2048
    v_mfma_f32_16x16x32_bf16 v[180:183], v[44:47], v[212:215], v[180:183]
    ds_read_b64_tr_b16 v[222:223], v3 offset:2064
    v_mfma_f32_16x16x32_bf16 v[184:187], v[60:63], v[212:215], v[184:187]
    ds_read_b128 v[232:235], v242 offset:2560
    v_mfma_f32_16x16x32_bf16 v[188:191], v[76:79], v[212:215], v[188:191]
    v_mfma_f32_16x16x32_bf16 v[12:15], v[224:227], v[236:239], v[12:15]
    v_mfma_f32_16x16x32_bf16 v[192:195], v[92:95], v[212:215], v[192:195]
    ds_read_b64_tr_b16 v[224:225], v3 offset:2176
    v_bfi_b32 v240, v5, 0, v179
    v_mfma_f32_16x16x32_bf16 v[196:199], v[108:111], v[212:215], v[196:199]
    ds_bpermute_b32 v240, v4, v240
    v_add_f32 v146, v146, v177
    v_mfma_f32_16x16x32_bf16 v[200:203], v[124:127], v[212:215], v[200:203]
    ds_read_b64_tr_b16 v[226:227], v3 offset:2192
    v_add_f32 v147, v147, v178
    v_mfma_f32_16x16x32_bf16 v[204:207], v[140:143], v[212:215], v[204:207]
    s_waitcnt lgkmcnt(3)
    ds_read_b128 v[212:215], v247 offset:12288
    v_add_f32 v145, v145, v176
    v_mfma_f32_16x16x32_bf16 v[12:15], v[216:219], v[228:231], v[12:15]
    ds_read_b128 v[236:239], v243 offset:2560
    v_cvt_pk_bf16_f32 v9, v146, v147
    v_mfma_f32_16x16x32_bf16 v[148:151], v[16:19], v[208:211], v[148:151]
    ds_read_b64_tr_b16 v[216:217], v3 offset:2304
    v_mfma_f32_16x16x32_bf16 v[152:155], v[32:35], v[208:211], v[152:155]
    s_waitcnt lgkmcnt(4)
    ds_read_b64_tr_b16 v[218:219], v3 offset:2320
    v_add_f32 v144, v144, v240
    v_mfma_f32_16x16x32_bf16 v[156:159], v[48:51], v[208:211], v[156:159]
    ds_read_b128 v[228:231], v244 offset:2560
    v_cvt_pk_bf16_f32 v8, v144, v145
    v_mfma_f32_16x16x32_bf16 v[160:163], v[64:67], v[208:211], v[160:163]
    v_mfma_f32_16x16x32_bf16 v[12:15], v[220:223], v[232:235], v[12:15]
    ds_read_b64_tr_b16 v[220:221], v3 offset:2432
    v_mfma_f32_16x16x32_bf16 v[164:167], v[80:83], v[208:211], v[164:167]
    ds_read_b64_tr_b16 v[222:223], v3 offset:2448
    v_mfma_f32_16x16x32_bf16 v[168:171], v[96:99], v[208:211], v[168:171]
    ds_read_b128 v[232:235], v245 offset:2560
    v_mfma_f32_16x16x32_bf16 v[172:175], v[112:115], v[208:211], v[172:175]
    s_waitcnt lgkmcnt(4)
    ds_read_b128 v[208:211], v248 offset:12288
    v_mfma_f32_16x16x32_bf16 v[180:183], v[16:19], v[212:215], v[180:183]
    v_mfma_f32_16x16x32_bf16 v[12:15], v[224:227], v[236:239], v[12:15]
    ds_read_b64_tr_b16 v[224:225], v3 offset:2560
    v_mfma_f32_16x16x32_bf16 v[184:187], v[32:35], v[212:215], v[184:187]
    ds_read_b64_tr_b16 v[226:227], v3 offset:2576
    v_mfma_f32_16x16x32_bf16 v[188:191], v[48:51], v[212:215], v[188:191]
    ds_read_b128 v[236:239], v242 offset:3072
    v_mfma_f32_16x16x32_bf16 v[192:195], v[64:67], v[212:215], v[192:195]
    s_waitcnt lgkmcnt(4)
    v_mfma_f32_16x16x32_bf16 v[12:15], v[216:219], v[228:231], v[12:15]
    v_mfma_f32_16x16x32_bf16 v[196:199], v[80:83], v[212:215], v[196:199]
    ds_read_b64_tr_b16 v[216:217], v3 offset:2688
    v_mfma_f32_16x16x32_bf16 v[200:203], v[96:99], v[212:215], v[200:203]
    ds_read_b64_tr_b16 v[218:219], v3 offset:2704
    v_mfma_f32_16x16x32_bf16 v[204:207], v[112:115], v[212:215], v[204:207]
    s_waitcnt lgkmcnt(3)
    ds_read_b128 v[212:215], v249 offset:12288
    v_mfma_f32_16x16x32_bf16 v[148:151], v[20:23], v[208:211], v[148:151]
    ds_read_b128 v[228:231], v243 offset:3072
    v_mfma_f32_16x16x32_bf16 v[12:15], v[220:223], v[232:235], v[12:15]
    v_mfma_f32_16x16x32_bf16 v[152:155], v[36:39], v[208:211], v[152:155]
    ds_read_b64_tr_b16 v[220:221], v3 offset:2816
    v_mfma_f32_16x16x32_bf16 v[156:159], v[52:55], v[208:211], v[156:159]
    ds_read_b64_tr_b16 v[222:223], v3 offset:2832
    v_mfma_f32_16x16x32_bf16 v[160:163], v[68:71], v[208:211], v[160:163]
    ds_read_b128 v[232:235], v244 offset:3072
    v_mfma_f32_16x16x32_bf16 v[164:167], v[84:87], v[208:211], v[164:167]
    s_waitcnt lgkmcnt(4)
    v_mfma_f32_16x16x32_bf16 v[12:15], v[224:227], v[236:239], v[12:15]
    v_mfma_f32_16x16x32_bf16 v[168:171], v[100:103], v[208:211], v[168:171]
    ds_read_b64_tr_b16 v[224:225], v3 offset:2944
    v_mfma_f32_16x16x32_bf16 v[172:175], v[116:119], v[208:211], v[172:175]
    ds_read_b128 v[208:211], v250 offset:12288
    v_mfma_f32_16x16x32_bf16 v[180:183], v[20:23], v[212:215], v[180:183]
    ds_read_b64_tr_b16 v[226:227], v3 offset:2960
    v_mfma_f32_16x16x32_bf16 v[184:187], v[36:39], v[212:215], v[184:187]
    s_waitcnt lgkmcnt(3)
    ds_read_b128 v[236:239], v245 offset:3072
    v_mfma_f32_16x16x32_bf16 v[12:15], v[216:219], v[228:231], v[12:15]
    ds_read_b64_tr_b16 v[216:217], v3 offset:3072
    v_mfma_f32_16x16x32_bf16 v[188:191], v[52:55], v[212:215], v[188:191]
    ds_read_b64_tr_b16 v[218:219], v3 offset:3088
    v_mfma_f32_16x16x32_bf16 v[192:195], v[68:71], v[212:215], v[192:195]
    ds_read_b128 v[228:231], v242 offset:3584
    v_mfma_f32_16x16x32_bf16 v[196:199], v[84:87], v[212:215], v[196:199]
    v_mfma_f32_16x16x32_bf16 v[200:203], v[100:103], v[212:215], v[200:203]
    v_mfma_f32_16x16x32_bf16 v[12:15], v[220:223], v[232:235], v[12:15]
    ds_read_b64_tr_b16 v[220:221], v3 offset:3200
    v_mfma_f32_16x16x32_bf16 v[204:207], v[116:119], v[212:215], v[204:207]
    s_waitcnt lgkmcnt(3)
    ds_read_b128 v[212:215], v251 offset:12288
    v_mfma_f32_16x16x32_bf16 v[148:151], v[24:27], v[208:211], v[148:151]
    ds_read_b64_tr_b16 v[222:223], v3 offset:3216
    v_mfma_f32_16x16x32_bf16 v[152:155], v[40:43], v[208:211], v[152:155]
    ds_read_b128 v[232:235], v243 offset:3584
    v_mfma_f32_16x16x32_bf16 v[156:159], v[56:59], v[208:211], v[156:159]
    v_mfma_f32_16x16x32_bf16 v[12:15], v[224:227], v[236:239], v[12:15]
    ds_read_b64_tr_b16 v[224:225], v3 offset:3328
    v_mfma_f32_16x16x32_bf16 v[160:163], v[72:75], v[208:211], v[160:163]
    ds_read_b64_tr_b16 v[226:227], v3 offset:3344
    v_mfma_f32_16x16x32_bf16 v[164:167], v[88:91], v[208:211], v[164:167]
    ds_read_b128 v[236:239], v244 offset:3584
    v_mfma_f32_16x16x32_bf16 v[168:171], v[104:107], v[208:211], v[168:171]
    s_waitcnt lgkmcnt(4)
    v_mfma_f32_16x16x32_bf16 v[12:15], v[216:219], v[228:231], v[12:15]
    v_mfma_f32_16x16x32_bf16 v[172:175], v[120:123], v[208:211], v[172:175]
    ds_read_b128 v[208:211], v252 offset:12288
    v_mfma_f32_16x16x32_bf16 v[180:183], v[24:27], v[212:215], v[180:183]
    ds_read_b64_tr_b16 v[216:217], v3 offset:3456
    v_mfma_f32_16x16x32_bf16 v[184:187], v[40:43], v[212:215], v[184:187]
    ds_read_b64_tr_b16 v[218:219], v3 offset:3472
    v_mfma_f32_16x16x32_bf16 v[188:191], v[56:59], v[212:215], v[188:191]
    s_waitcnt lgkmcnt(3)
    ds_read_b128 v[228:231], v245 offset:3584
    v_mfma_f32_16x16x32_bf16 v[12:15], v[220:223], v[232:235], v[12:15]
    v_mfma_f32_16x16x32_bf16 v[192:195], v[72:75], v[212:215], v[192:195]
    ds_read_b64_tr_b16 v[220:221], v3 offset:0
    v_mfma_f32_16x16x32_bf16 v[196:199], v[88:91], v[212:215], v[196:199]
    ds_read_b64_tr_b16 v[222:223], v3 offset:16
    v_mfma_f32_16x16x32_bf16 v[200:203], v[104:107], v[212:215], v[200:203]
    ds_read_b128 v[232:235], v242 offset:3072
    v_mfma_f32_16x16x32_bf16 v[204:207], v[120:123], v[212:215], v[204:207]
    ds_read_b128 v[212:215], v253 offset:12288
    v_mfma_f32_16x16x32_bf16 v[12:15], v[224:227], v[236:239], v[12:15]
    s_waitcnt lgkmcnt(4)
    v_mfma_f32_16x16x32_bf16 v[148:151], v[28:31], v[208:211], v[148:151]
    ds_read_b64_tr_b16 v[224:225], v3 offset:128
    v_mfma_f32_16x16x32_bf16 v[152:155], v[44:47], v[208:211], v[152:155]
    ds_read_b64_tr_b16 v[226:227], v3 offset:144
    v_mfma_f32_16x16x32_bf16 v[156:159], v[60:63], v[208:211], v[156:159]
    ds_read_b128 v[236:239], v243 offset:3072
    v_mfma_f32_16x16x32_bf16 v[160:163], v[76:79], v[208:211], v[160:163]
    v_mfma_f32_16x16x32_bf16 v[12:15], v[216:219], v[228:231], v[12:15]
    ds_read_b64_tr_b16 v[216:217], v3 offset:256
    v_mfma_f32_16x16x32_bf16 v[164:167], v[92:95], v[208:211], v[164:167]
    ds_read_b64_tr_b16 v[218:219], v3 offset:272
    v_mfma_f32_16x16x32_bf16 v[168:171], v[108:111], v[208:211], v[168:171]
    ds_read_b128 v[228:231], v244 offset:3072
    v_mfma_f32_16x16x32_bf16 v[172:175], v[124:127], v[208:211], v[172:175]
    s_waitcnt lgkmcnt(4)
    ds_read_b128 v[208:211], v246 offset:10240
    v_mfma_f32_16x16x32_bf16 v[180:183], v[28:31], v[212:215], v[180:183]
    v_mfma_f32_16x16x32_bf16 v[140:143], v[220:223], v[232:235], 0
    ds_read_b64_tr_b16 v[220:221], v3 offset:384
    v_mfma_f32_16x16x32_bf16 v[184:187], v[44:47], v[212:215], v[184:187]
    ds_read_b64_tr_b16 v[222:223], v3 offset:400
    v_mfma_f32_16x16x32_bf16 v[188:191], v[60:63], v[212:215], v[188:191]
    ds_read_b128 v[232:235], v245 offset:3072
    v_mfma_f32_16x16x32_bf16 v[192:195], v[76:79], v[212:215], v[192:195]
    v_mfma_f32_16x16x32_bf16 v[196:199], v[92:95], v[212:215], v[196:199]
    s_waitcnt lgkmcnt(3)
    v_bfi_b32 v241, v5, v179, v183
    v_add_f32 v150, v150, v181
    v_mfma_f32_16x16x32_bf16 v[140:143], v[224:227], v[236:239], v[140:143]
    ds_bpermute_b32 v241, v4, v241
    v_add_f32 v151, v151, v182
    v_mfma_f32_16x16x32_bf16 v[200:203], v[108:111], v[212:215], v[200:203]
    ds_read_b64_tr_b16 v[224:225], v3 offset:512
    v_add_f32 v149, v149, v180
    v_mfma_f32_16x16x32_bf16 v[204:207], v[124:127], v[212:215], v[204:207]
    ds_read_b128 v[212:215], v247 offset:10240
    v_cvt_pk_bf16_f32 v11, v150, v151
    v_mfma_f32_16x16x32_bf16 v[152:155], v[16:19], v[208:211], v[152:155]
    ds_read_b64_tr_b16 v[226:227], v3 offset:528
    v_mfma_f32_16x16x32_bf16 v[140:143], v[216:219], v[228:231], v[140:143]
    ds_read_b128 v[236:239], v242 offset:3584
    v_mfma_f32_16x16x32_bf16 v[156:159], v[32:35], v[208:211], v[156:159]
    s_waitcnt lgkmcnt(4)
    ds_read_b64_tr_b16 v[216:217], v3 offset:640
    v_add_f32 v148, v148, v241
    v_mfma_f32_16x16x32_bf16 v[160:163], v[48:51], v[208:211], v[160:163]
    ds_read_b64_tr_b16 v[218:219], v3 offset:656
    v_cvt_pk_bf16_f32 v10, v148, v149
    v_mfma_f32_16x16x32_bf16 v[164:167], v[64:67], v[208:211], v[164:167]
    ds_read_b128 v[228:231], v243 offset:3584
    v_permlane16_swap_b32 v9, v11
    v_mfma_f32_16x16x32_bf16 v[168:171], v[80:83], v[208:211], v[168:171]
    v_mfma_f32_16x16x32_bf16 v[140:143], v[220:223], v[232:235], v[140:143]
    v_permlane16_swap_b32 v8, v10
    v_mfma_f32_16x16x32_bf16 v[172:175], v[96:99], v[208:211], v[172:175]
    s_waitcnt lgkmcnt(3)
    buffer_store_dwordx4 v[8:11], v6, s[36:39], s52 offen sc1
    v_mfma_f32_16x16x32_bf16 v[184:187], v[16:19], v[212:215], v[184:187]
    ds_read_b128 v[208:211], v248 offset:10240
    v_mfma_f32_16x16x32_bf16 v[188:191], v[32:35], v[212:215], v[188:191]
    ds_read_b64_tr_b16 v[220:221], v3 offset:768
    v_mfma_f32_16x16x32_bf16 v[192:195], v[48:51], v[212:215], v[192:195]
    ds_read_b64_tr_b16 v[222:223], v3 offset:784
    v_mfma_f32_16x16x32_bf16 v[140:143], v[224:227], v[236:239], v[140:143]
    ds_read_b128 v[232:235], v244 offset:3584
    v_mfma_f32_16x16x32_bf16 v[196:199], v[64:67], v[212:215], v[196:199]
    ds_read_b64_tr_b16 v[224:225], v3 offset:896
    v_mfma_f32_16x16x32_bf16 v[200:203], v[80:83], v[212:215], v[200:203]
    ds_read_b64_tr_b16 v[226:227], v3 offset:912
    s_branch L_mt_s
L_mv2_s:
    v_mfma_f32_16x16x32_bf16 v[144:147], v[16:19], v[208:211], 0
    ds_read_b64_tr_b16 v[216:217], v3 offset:0
    v_mfma_f32_16x16x32_bf16 v[148:151], v[32:35], v[208:211], 0
    ds_read_b64_tr_b16 v[218:219], v3 offset:16
    v_mfma_f32_16x16x32_bf16 v[152:155], v[48:51], v[208:211], 0
    ds_read_b128 v[228:231], v242 offset:1024
    v_mfma_f32_16x16x32_bf16 v[156:159], v[64:67], v[208:211], 0
    ds_read_b64_tr_b16 v[220:221], v3 offset:128
    v_mfma_f32_16x16x32_bf16 v[160:163], v[80:83], v[208:211], 0
    ds_read_b64_tr_b16 v[222:223], v3 offset:144
    v_mfma_f32_16x16x32_bf16 v[164:167], v[96:99], v[208:211], 0
    ds_read_b128 v[232:235], v243 offset:1024
    v_mfma_f32_16x16x32_bf16 v[168:171], v[112:115], v[208:211], 0
    s_waitcnt lgkmcnt(3)
    ds_read_b64_tr_b16 v[224:225], v3 offset:256
    v_mfma_f32_16x16x32_bf16 v[12:15], v[216:219], v[228:231], 0
    ds_read_b64_tr_b16 v[226:227], v3 offset:272
    v_mfma_f32_16x16x32_bf16 v[172:175], v[128:131], v[208:211], 0
    ds_read_b128 v[236:239], v244 offset:1024
    v_mfma_f32_16x16x32_bf16 v[176:179], v[16:19], v[212:215], 0
    ds_read_b128 v[208:211], v248 offset:14336
    v_mfma_f32_16x16x32_bf16 v[180:183], v[32:35], v[212:215], 0
    s_waitcnt lgkmcnt(4)
    ds_read_b64_tr_b16 v[216:217], v3 offset:384
    v_mfma_f32_16x16x32_bf16 v[12:15], v[220:223], v[232:235], v[12:15]
    ds_read_b64_tr_b16 v[218:219], v3 offset:400
    v_mfma_f32_16x16x32_bf16 v[184:187], v[48:51], v[212:215], 0
    ds_read_b128 v[228:231], v245 offset:1024
    v_mfma_f32_16x16x32_bf16 v[188:191], v[64:67], v[212:215], 0
    ds_read_b64_tr_b16 v[220:221], v3 offset:512
    v_mfma_f32_16x16x32_bf16 v[192:195], v[80:83], v[212:215], 0
    ds_read_b64_tr_b16 v[222:223], v3 offset:528
    v_mfma_f32_16x16x32_bf16 v[196:199], v[96:99], v[212:215], 0
    s_waitcnt lgkmcnt(5)
    ds_read_b128 v[232:235], v242 offset:1536
    v_mfma_f32_16x16x32_bf16 v[12:15], v[224:227], v[236:239], v[12:15]
    v_mfma_f32_16x16x32_bf16 v[200:203], v[112:115], v[212:215], 0
    ds_read_b64_tr_b16 v[224:225], v3 offset:640
    v_mfma_f32_16x16x32_bf16 v[204:207], v[128:131], v[212:215], 0
    ds_read_b128 v[212:215], v249 offset:14336
    v_mfma_f32_16x16x32_bf16 v[144:147], v[20:23], v[208:211], v[144:147]
    ds_read_b64_tr_b16 v[226:227], v3 offset:656
    v_mfma_f32_16x16x32_bf16 v[148:151], v[36:39], v[208:211], v[148:151]
    s_waitcnt lgkmcnt(4)
    ds_read_b128 v[236:239], v243 offset:1536
    v_mfma_f32_16x16x32_bf16 v[12:15], v[216:219], v[228:231], v[12:15]
    ds_read_b64_tr_b16 v[216:217], v3 offset:768
    v_mfma_f32_16x16x32_bf16 v[152:155], v[52:55], v[208:211], v[152:155]
    ds_read_b64_tr_b16 v[218:219], v3 offset:784
    v_mfma_f32_16x16x32_bf16 v[156:159], v[68:71], v[208:211], v[156:159]
    ds_read_b128 v[228:231], v244 offset:1536
    v_mfma_f32_16x16x32_bf16 v[160:163], v[84:87], v[208:211], v[160:163]
    v_mfma_f32_16x16x32_bf16 v[164:167], v[100:103], v[208:211], v[164:167]
    s_waitcnt lgkmcnt(4)
    v_mfma_f32_16x16x32_bf16 v[12:15], v[220:223], v[232:235], v[12:15]
    ds_read_b64_tr_b16 v[220:221], v3 offset:896
    v_mfma_f32_16x16x32_bf16 v[168:171], v[116:119], v[208:211], v[168:171]
    ds_read_b64_tr_b16 v[222:223], v3 offset:912
    v_mfma_f32_16x16x32_bf16 v[172:175], v[132:135], v[208:211], v[172:175]
    ds_read_b128 v[208:211], v250 offset:14336
    v_mfma_f32_16x16x32_bf16 v[176:179], v[20:23], v[212:215], v[176:179]
    ds_read_b128 v[232:235], v245 offset:1536
    v_mfma_f32_16x16x32_bf16 v[180:183], v[36:39], v[212:215], v[180:183]
    s_waitcnt lgkmcnt(4)
    v_mfma_f32_16x16x32_bf16 v[12:15], v[224:227], v[236:239], v[12:15]
    ds_read_b64_tr_b16 v[224:225], v3 offset:1024
    v_mfma_f32_16x16x32_bf16 v[184:187], v[52:55], v[212:215], v[184:187]
    ds_read_b64_tr_b16 v[226:227], v3 offset:1040
    v_mfma_f32_16x16x32_bf16 v[188:191], v[68:71], v[212:215], v[188:191]
    ds_read_b128 v[236:239], v242 offset:2048
    v_mfma_f32_16x16x32_bf16 v[192:195], v[84:87], v[212:215], v[192:195]
    v_mfma_f32_16x16x32_bf16 v[12:15], v[216:219], v[228:231], v[12:15]
    v_mfma_f32_16x16x32_bf16 v[196:199], v[100:103], v[212:215], v[196:199]
    ds_read_b64_tr_b16 v[216:217], v3 offset:1152
    v_mfma_f32_16x16x32_bf16 v[200:203], v[116:119], v[212:215], v[200:203]
    ds_read_b64_tr_b16 v[218:219], v3 offset:1168
    v_mfma_f32_16x16x32_bf16 v[204:207], v[132:135], v[212:215], v[204:207]
    s_waitcnt lgkmcnt(3)
    ds_read_b128 v[212:215], v251 offset:14336
    v_mfma_f32_16x16x32_bf16 v[144:147], v[24:27], v[208:211], v[144:147]
    ds_read_b128 v[228:231], v243 offset:2048
    v_mfma_f32_16x16x32_bf16 v[12:15], v[220:223], v[232:235], v[12:15]
    v_mfma_f32_16x16x32_bf16 v[148:151], v[40:43], v[208:211], v[148:151]
    ds_read_b64_tr_b16 v[220:221], v3 offset:1280
    v_mfma_f32_16x16x32_bf16 v[152:155], v[56:59], v[208:211], v[152:155]
    ds_read_b64_tr_b16 v[222:223], v3 offset:1296
    v_mfma_f32_16x16x32_bf16 v[156:159], v[72:75], v[208:211], v[156:159]
    ds_read_b128 v[232:235], v244 offset:2048
    v_mfma_f32_16x16x32_bf16 v[160:163], v[88:91], v[208:211], v[160:163]
    s_waitcnt lgkmcnt(4)
    v_mfma_f32_16x16x32_bf16 v[12:15], v[224:227], v[236:239], v[12:15]
    v_mfma_f32_16x16x32_bf16 v[164:167], v[104:107], v[208:211], v[164:167]
    ds_read_b64_tr_b16 v[224:225], v3 offset:1408
    v_mfma_f32_16x16x32_bf16 v[168:171], v[120:123], v[208:211], v[168:171]
    ds_read_b64_tr_b16 v[226:227], v3 offset:1424
    v_mfma_f32_16x16x32_bf16 v[172:175], v[136:139], v[208:211], v[172:175]
    ds_read_b128 v[208:211], v252 offset:14336
    v_mfma_f32_16x16x32_bf16 v[176:179], v[24:27], v[212:215], v[176:179]
    s_waitcnt lgkmcnt(3)
    ds_read_b128 v[236:239], v245 offset:2048
    v_mfma_f32_16x16x32_bf16 v[12:15], v[216:219], v[228:231], v[12:15]
    ds_read_b64_tr_b16 v[216:217], v3 offset:1536
    v_mfma_f32_16x16x32_bf16 v[180:183], v[40:43], v[212:215], v[180:183]
    ds_read_b64_tr_b16 v[218:219], v3 offset:1552
    v_mfma_f32_16x16x32_bf16 v[184:187], v[56:59], v[212:215], v[184:187]
    ds_read_b128 v[228:231], v242 offset:2560
    v_mfma_f32_16x16x32_bf16 v[188:191], v[72:75], v[212:215], v[188:191]
    v_mfma_f32_16x16x32_bf16 v[192:195], v[88:91], v[212:215], v[192:195]
    v_mfma_f32_16x16x32_bf16 v[12:15], v[220:223], v[232:235], v[12:15]
    ds_read_b64_tr_b16 v[220:221], v3 offset:1664
    v_mfma_f32_16x16x32_bf16 v[196:199], v[104:107], v[212:215], v[196:199]
    ds_read_b64_tr_b16 v[222:223], v3 offset:1680
    v_mfma_f32_16x16x32_bf16 v[200:203], v[120:123], v[212:215], v[200:203]
    ds_read_b128 v[232:235], v243 offset:2560
    v_mfma_f32_16x16x32_bf16 v[204:207], v[136:139], v[212:215], v[204:207]
    s_waitcnt lgkmcnt(3)
    ds_read_b128 v[212:215], v253 offset:14336
    v_mfma_f32_16x16x32_bf16 v[144:147], v[28:31], v[208:211], v[144:147]
    v_mfma_f32_16x16x32_bf16 v[12:15], v[224:227], v[236:239], v[12:15]
    ds_read_b64_tr_b16 v[224:225], v3 offset:1792
    v_mfma_f32_16x16x32_bf16 v[148:151], v[44:47], v[208:211], v[148:151]
    ds_read_b64_tr_b16 v[226:227], v3 offset:1808
    v_mfma_f32_16x16x32_bf16 v[152:155], v[60:63], v[208:211], v[152:155]
    ds_read_b128 v[236:239], v244 offset:2560
    v_mfma_f32_16x16x32_bf16 v[156:159], v[76:79], v[208:211], v[156:159]
    v_mfma_f32_16x16x32_bf16 v[12:15], v[216:219], v[228:231], v[12:15]
    v_mfma_f32_16x16x32_bf16 v[160:163], v[92:95], v[208:211], v[160:163]
    ds_read_b64_tr_b16 v[216:217], v3 offset:1920
    v_mfma_f32_16x16x32_bf16 v[164:167], v[108:111], v[208:211], v[164:167]
    ds_read_b64_tr_b16 v[218:219], v3 offset:1936
    v_mfma_f32_16x16x32_bf16 v[168:171], v[124:127], v[208:211], v[168:171]
    ds_read_b128 v[228:231], v245 offset:2560
    v_mfma_f32_16x16x32_bf16 v[172:175], v[140:143], v[208:211], v[172:175]
    s_waitcnt lgkmcnt(3)
    ds_read_b128 v[208:211], v246 offset:12288
    v_mfma_f32_16x16x32_bf16 v[12:15], v[220:223], v[232:235], v[12:15]
    v_mfma_f32_16x16x32_bf16 v[176:179], v[28:31], v[212:215], v[176:179]
    ds_read_b64_tr_b16 v[220:221], v3 offset:2048
    v_mfma_f32_16x16x32_bf16 v[180:183], v[44:47], v[212:215], v[180:183]
    ds_read_b64_tr_b16 v[222:223], v3 offset:2064
    v_mfma_f32_16x16x32_bf16 v[184:187], v[60:63], v[212:215], v[184:187]
    ds_read_b128 v[232:235], v242 offset:3072
    v_mfma_f32_16x16x32_bf16 v[188:191], v[76:79], v[212:215], v[188:191]
    v_mfma_f32_16x16x32_bf16 v[12:15], v[224:227], v[236:239], v[12:15]
    v_mfma_f32_16x16x32_bf16 v[192:195], v[92:95], v[212:215], v[192:195]
    ds_read_b64_tr_b16 v[224:225], v3 offset:2176
    v_bfi_b32 v240, v5, 0, v179
    v_mfma_f32_16x16x32_bf16 v[196:199], v[108:111], v[212:215], v[196:199]
    ds_bpermute_b32 v240, v4, v240
    v_add_f32 v146, v146, v177
    v_mfma_f32_16x16x32_bf16 v[200:203], v[124:127], v[212:215], v[200:203]
    ds_read_b64_tr_b16 v[226:227], v3 offset:2192
    v_add_f32 v147, v147, v178
    v_mfma_f32_16x16x32_bf16 v[204:207], v[140:143], v[212:215], v[204:207]
    s_waitcnt lgkmcnt(3)
    ds_read_b128 v[212:215], v247 offset:12288
    v_add_f32 v145, v145, v176
    v_mfma_f32_16x16x32_bf16 v[12:15], v[216:219], v[228:231], v[12:15]
    ds_read_b128 v[236:239], v243 offset:3072
    v_cvt_pk_bf16_f32 v9, v146, v147
    v_mfma_f32_16x16x32_bf16 v[148:151], v[16:19], v[208:211], v[148:151]
    ds_read_b64_tr_b16 v[216:217], v3 offset:2304
    v_mfma_f32_16x16x32_bf16 v[152:155], v[32:35], v[208:211], v[152:155]
    s_waitcnt lgkmcnt(4)
    ds_read_b64_tr_b16 v[218:219], v3 offset:2320
    v_add_f32 v144, v144, v240
    v_mfma_f32_16x16x32_bf16 v[156:159], v[48:51], v[208:211], v[156:159]
    ds_read_b128 v[228:231], v244 offset:3072
    v_cvt_pk_bf16_f32 v8, v144, v145
    v_mfma_f32_16x16x32_bf16 v[160:163], v[64:67], v[208:211], v[160:163]
    v_mfma_f32_16x16x32_bf16 v[12:15], v[220:223], v[232:235], v[12:15]
    ds_read_b64_tr_b16 v[220:221], v3 offset:2432
    v_mfma_f32_16x16x32_bf16 v[164:167], v[80:83], v[208:211], v[164:167]
    ds_read_b64_tr_b16 v[222:223], v3 offset:2448
    v_mfma_f32_16x16x32_bf16 v[168:171], v[96:99], v[208:211], v[168:171]
    ds_read_b128 v[232:235], v245 offset:3072
    v_mfma_f32_16x16x32_bf16 v[172:175], v[112:115], v[208:211], v[172:175]
    s_waitcnt lgkmcnt(4)
    ds_read_b128 v[208:211], v248 offset:12288
    v_mfma_f32_16x16x32_bf16 v[180:183], v[16:19], v[212:215], v[180:183]
    v_mfma_f32_16x16x32_bf16 v[12:15], v[224:227], v[236:239], v[12:15]
    ds_read_b64_tr_b16 v[224:225], v3 offset:2560
    v_mfma_f32_16x16x32_bf16 v[184:187], v[32:35], v[212:215], v[184:187]
    ds_read_b64_tr_b16 v[226:227], v3 offset:2576
    v_mfma_f32_16x16x32_bf16 v[188:191], v[48:51], v[212:215], v[188:191]
    ds_read_b128 v[236:239], v242 offset:3584
    v_mfma_f32_16x16x32_bf16 v[192:195], v[64:67], v[212:215], v[192:195]
    s_waitcnt lgkmcnt(4)
    v_mfma_f32_16x16x32_bf16 v[12:15], v[216:219], v[228:231], v[12:15]
    v_mfma_f32_16x16x32_bf16 v[196:199], v[80:83], v[212:215], v[196:199]
    ds_read_b64_tr_b16 v[216:217], v3 offset:2688
    v_mfma_f32_16x16x32_bf16 v[200:203], v[96:99], v[212:215], v[200:203]
    ds_read_b64_tr_b16 v[218:219], v3 offset:2704
    v_mfma_f32_16x16x32_bf16 v[204:207], v[112:115], v[212:215], v[204:207]
    s_waitcnt lgkmcnt(3)
    ds_read_b128 v[212:215], v249 offset:12288
    v_mfma_f32_16x16x32_bf16 v[148:151], v[20:23], v[208:211], v[148:151]
    ds_read_b128 v[228:231], v243 offset:3584
    v_mfma_f32_16x16x32_bf16 v[12:15], v[220:223], v[232:235], v[12:15]
    v_mfma_f32_16x16x32_bf16 v[152:155], v[36:39], v[208:211], v[152:155]
    ds_read_b64_tr_b16 v[220:221], v3 offset:2816
    v_mfma_f32_16x16x32_bf16 v[156:159], v[52:55], v[208:211], v[156:159]
    ds_read_b64_tr_b16 v[222:223], v3 offset:2832
    v_mfma_f32_16x16x32_bf16 v[160:163], v[68:71], v[208:211], v[160:163]
    ds_read_b128 v[232:235], v244 offset:3584
    v_mfma_f32_16x16x32_bf16 v[164:167], v[84:87], v[208:211], v[164:167]
    s_waitcnt lgkmcnt(4)
    v_mfma_f32_16x16x32_bf16 v[12:15], v[224:227], v[236:239], v[12:15]
    v_mfma_f32_16x16x32_bf16 v[168:171], v[100:103], v[208:211], v[168:171]
    ds_read_b64_tr_b16 v[224:225], v3 offset:2944
    v_mfma_f32_16x16x32_bf16 v[172:175], v[116:119], v[208:211], v[172:175]
    ds_read_b128 v[208:211], v250 offset:12288
    v_mfma_f32_16x16x32_bf16 v[180:183], v[20:23], v[212:215], v[180:183]
    ds_read_b64_tr_b16 v[226:227], v3 offset:2960
    v_mfma_f32_16x16x32_bf16 v[184:187], v[36:39], v[212:215], v[184:187]
    s_waitcnt lgkmcnt(3)
    ds_read_b128 v[236:239], v245 offset:3584
    v_mfma_f32_16x16x32_bf16 v[12:15], v[216:219], v[228:231], v[12:15]
    ds_read_b64_tr_b16 v[216:217], v3 offset:0
    v_mfma_f32_16x16x32_bf16 v[188:191], v[52:55], v[212:215], v[188:191]
    ds_read_b64_tr_b16 v[218:219], v3 offset:16
    v_mfma_f32_16x16x32_bf16 v[192:195], v[68:71], v[212:215], v[192:195]
    ds_read_b128 v[228:231], v242 offset:2560
    v_mfma_f32_16x16x32_bf16 v[196:199], v[84:87], v[212:215], v[196:199]
    v_mfma_f32_16x16x32_bf16 v[200:203], v[100:103], v[212:215], v[200:203]
    v_mfma_f32_16x16x32_bf16 v[12:15], v[220:223], v[232:235], v[12:15]
    ds_read_b64_tr_b16 v[220:221], v3 offset:128
    v_mfma_f32_16x16x32_bf16 v[204:207], v[116:119], v[212:215], v[204:207]
    s_waitcnt lgkmcnt(3)
    ds_read_b128 v[212:215], v251 offset:12288
    v_mfma_f32_16x16x32_bf16 v[148:151], v[24:27], v[208:211], v[148:151]
    ds_read_b64_tr_b16 v[222:223], v3 offset:144
    v_mfma_f32_16x16x32_bf16 v[152:155], v[40:43], v[208:211], v[152:155]
    ds_read_b128 v[232:235], v243 offset:2560
    v_mfma_f32_16x16x32_bf16 v[156:159], v[56:59], v[208:211], v[156:159]
    v_mfma_f32_16x16x32_bf16 v[12:15], v[224:227], v[236:239], v[12:15]
    ds_read_b64_tr_b16 v[224:225], v3 offset:256
    v_mfma_f32_16x16x32_bf16 v[160:163], v[72:75], v[208:211], v[160:163]
    ds_read_b64_tr_b16 v[226:227], v3 offset:272
    v_mfma_f32_16x16x32_bf16 v[164:167], v[88:91], v[208:211], v[164:167]
    ds_read_b128 v[236:239], v244 offset:2560
    v_mfma_f32_16x16x32_bf16 v[168:171], v[104:107], v[208:211], v[168:171]
    s_waitcnt lgkmcnt(4)
    v_mfma_f32_16x16x32_bf16 v[140:143], v[216:219], v[228:231], 0
    v_mfma_f32_16x16x32_bf16 v[172:175], v[120:123], v[208:211], v[172:175]
    ds_read_b128 v[208:211], v252 offset:12288
    v_mfma_f32_16x16x32_bf16 v[180:183], v[24:27], v[212:215], v[180:183]
    ds_read_b64_tr_b16 v[216:217], v3 offset:384
    v_mfma_f32_16x16x32_bf16 v[184:187], v[40:43], v[212:215], v[184:187]
    ds_read_b64_tr_b16 v[218:219], v3 offset:400
    v_mfma_f32_16x16x32_bf16 v[188:191], v[56:59], v[212:215], v[188:191]
    s_waitcnt lgkmcnt(3)
    ds_read_b128 v[228:231], v245 offset:2560
    v_mfma_f32_16x16x32_bf16 v[140:143], v[220:223], v[232:235], v[140:143]
    v_mfma_f32_16x16x32_bf16 v[192:195], v[72:75], v[212:215], v[192:195]
    ds_read_b64_tr_b16 v[220:221], v3 offset:512
    v_mfma_f32_16x16x32_bf16 v[196:199], v[88:91], v[212:215], v[196:199]
    ds_read_b64_tr_b16 v[222:223], v3 offset:528
    v_mfma_f32_16x16x32_bf16 v[200:203], v[104:107], v[212:215], v[200:203]
    ds_read_b128 v[232:235], v242 offset:3072
    v_mfma_f32_16x16x32_bf16 v[204:207], v[120:123], v[212:215], v[204:207]
    ds_read_b128 v[212:215], v253 offset:12288
    v_mfma_f32_16x16x32_bf16 v[140:143], v[224:227], v[236:239], v[140:143]
    s_waitcnt lgkmcnt(4)
    v_mfma_f32_16x16x32_bf16 v[148:151], v[28:31], v[208:211], v[148:151]
    ds_read_b64_tr_b16 v[224:225], v3 offset:640
    v_mfma_f32_16x16x32_bf16 v[152:155], v[44:47], v[208:211], v[152:155]
    ds_read_b64_tr_b16 v[226:227], v3 offset:656
    v_mfma_f32_16x16x32_bf16 v[156:159], v[60:63], v[208:211], v[156:159]
    ds_read_b128 v[236:239], v243 offset:3072
    v_mfma_f32_16x16x32_bf16 v[160:163], v[76:79], v[208:211], v[160:163]
    v_mfma_f32_16x16x32_bf16 v[140:143], v[216:219], v[228:231], v[140:143]
    ds_read_b64_tr_b16 v[216:217], v3 offset:768
    v_mfma_f32_16x16x32_bf16 v[164:167], v[92:95], v[208:211], v[164:167]
    ds_read_b64_tr_b16 v[218:219], v3 offset:784
    v_mfma_f32_16x16x32_bf16 v[168:171], v[108:111], v[208:211], v[168:171]
    ds_read_b128 v[228:231], v244 offset:3072
    v_mfma_f32_16x16x32_bf16 v[172:175], v[124:127], v[208:211], v[172:175]
    s_waitcnt lgkmcnt(4)
    ds_read_b128 v[208:211], v246 offset:10240
    v_mfma_f32_16x16x32_bf16 v[180:183], v[28:31], v[212:215], v[180:183]
    v_mfma_f32_16x16x32_bf16 v[140:143], v[220:223], v[232:235], v[140:143]
    ds_read_b64_tr_b16 v[220:221], v3 offset:896
    v_mfma_f32_16x16x32_bf16 v[184:187], v[44:47], v[212:215], v[184:187]
    ds_read_b64_tr_b16 v[222:223], v3 offset:912
    v_mfma_f32_16x16x32_bf16 v[188:191], v[60:63], v[212:215], v[188:191]
    ds_read_b128 v[232:235], v245 offset:3072
    v_mfma_f32_16x16x32_bf16 v[192:195], v[76:79], v[212:215], v[192:195]
    v_mfma_f32_16x16x32_bf16 v[196:199], v[92:95], v[212:215], v[196:199]
    s_waitcnt lgkmcnt(3)
    v_bfi_b32 v241, v5, v179, v183
    v_add_f32 v150, v150, v181
    v_mfma_f32_16x16x32_bf16 v[140:143], v[224:227], v[236:239], v[140:143]
    ds_bpermute_b32 v241, v4, v241
    v_add_f32 v151, v151, v182
    v_mfma_f32_16x16x32_bf16 v[200:203], v[108:111], v[212:215], v[200:203]
    ds_read_b64_tr_b16 v[224:225], v3 offset:1024
    v_add_f32 v149, v149, v180
    v_mfma_f32_16x16x32_bf16 v[204:207], v[124:127], v[212:215], v[204:207]
    ds_read_b128 v[212:215], v247 offset:10240
    v_cvt_pk_bf16_f32 v11, v150, v151
    v_mfma_f32_16x16x32_bf16 v[152:155], v[16:19], v[208:211], v[152:155]
    ds_read_b64_tr_b16 v[226:227], v3 offset:1040
    v_mfma_f32_16x16x32_bf16 v[140:143], v[216:219], v[228:231], v[140:143]
    ds_read_b128 v[236:239], v242 offset:3584
    v_mfma_f32_16x16x32_bf16 v[156:159], v[32:35], v[208:211], v[156:159]
    s_waitcnt lgkmcnt(4)
    ds_read_b64_tr_b16 v[216:217], v3 offset:1152
    v_add_f32 v148, v148, v241
    v_mfma_f32_16x16x32_bf16 v[160:163], v[48:51], v[208:211], v[160:163]
    ds_read_b64_tr_b16 v[218:219], v3 offset:1168
    v_cvt_pk_bf16_f32 v10, v148, v149
    v_mfma_f32_16x16x32_bf16 v[164:167], v[64:67], v[208:211], v[164:167]
    ds_read_b128 v[228:231], v243 offset:3584
    v_permlane16_swap_b32 v9, v11
    v_mfma_f32_16x16x32_bf16 v[168:171], v[80:83], v[208:211], v[168:171]
    v_mfma_f32_16x16x32_bf16 v[140:143], v[220:223], v[232:235], v[140:143]
    v_permlane16_swap_b32 v8, v10
    v_mfma_f32_16x16x32_bf16 v[172:175], v[96:99], v[208:211], v[172:175]
    s_waitcnt lgkmcnt(3)
    buffer_store_dwordx4 v[8:11], v6, s[36:39], s52 offen sc1
    v_mfma_f32_16x16x32_bf16 v[184:187], v[16:19], v[212:215], v[184:187]
    ds_read_b128 v[208:211], v248 offset:10240
    v_mfma_f32_16x16x32_bf16 v[188:191], v[32:35], v[212:215], v[188:191]
    ds_read_b64_tr_b16 v[220:221], v3 offset:1280
    v_mfma_f32_16x16x32_bf16 v[192:195], v[48:51], v[212:215], v[192:195]
    ds_read_b64_tr_b16 v[222:223], v3 offset:1296
    v_mfma_f32_16x16x32_bf16 v[140:143], v[224:227], v[236:239], v[140:143]
    ds_read_b128 v[232:235], v244 offset:3584
    v_mfma_f32_16x16x32_bf16 v[196:199], v[64:67], v[212:215], v[196:199]
    ds_read_b64_tr_b16 v[224:225], v3 offset:1408
    v_mfma_f32_16x16x32_bf16 v[200:203], v[80:83], v[212:215], v[200:203]
    ds_read_b64_tr_b16 v[226:227], v3 offset:1424
    s_branch L_mt_s
L_mv3_s:
    v_mfma_f32_16x16x32_bf16 v[144:147], v[16:19], v[208:211], 0
    ds_read_b64_tr_b16 v[216:217], v3 offset:0
    v_mfma_f32_16x16x32_bf16 v[148:151], v[32:35], v[208:211], 0
    ds_read_b64_tr_b16 v[218:219], v3 offset:16
    v_mfma_f32_16x16x32_bf16 v[152:155], v[48:51], v[208:211], 0
    ds_read_b128 v[228:231], v242 offset:1536
    v_mfma_f32_16x16x32_bf16 v[156:159], v[64:67], v[208:211], 0
    ds_read_b64_tr_b16 v[220:221], v3 offset:128
    v_mfma_f32_16x16x32_bf16 v[160:163], v[80:83], v[208:211], 0
    ds_read_b64_tr_b16 v[222:223], v3 offset:144
    v_mfma_f32_16x16x32_bf16 v[164:167], v[96:99], v[208:211], 0
    ds_read_b128 v[232:235], v243 offset:1536
    v_mfma_f32_16x16x32_bf16 v[168:171], v[112:115], v[208:211], 0
    s_waitcnt lgkmcnt(3)
    ds_read_b64_tr_b16 v[224:225], v3 offset:256
    v_mfma_f32_16x16x32_bf16 v[12:15], v[216:219], v[228:231], 0
    ds_read_b64_tr_b16 v[226:227], v3 offset:272
    v_mfma_f32_16x16x32_bf16 v[172:175], v[128:131], v[208:211], 0
    ds_read_b128 v[236:239], v244 offset:1536
    v_mfma_f32_16x16x32_bf16 v[176:179], v[16:19], v[212:215], 0
    ds_read_b128 v[208:211], v248 offset:14336
    v_mfma_f32_16x16x32_bf16 v[180:183], v[32:35], v[212:215], 0
    s_waitcnt lgkmcnt(4)
    ds_read_b64_tr_b16 v[216:217], v3 offset:384
    v_mfma_f32_16x16x32_bf16 v[12:15], v[220:223], v[232:235], v[12:15]
    ds_read_b64_tr_b16 v[218:219], v3 offset:400
    v_mfma_f32_16x16x32_bf16 v[184:187], v[48:51], v[212:215], 0
    ds_read_b128 v[228:231], v245 offset:1536
    v_mfma_f32_16x16x32_bf16 v[188:191], v[64:67], v[212:215], 0
    ds_read_b64_tr_b16 v[220:221], v3 offset:512
    v_mfma_f32_16x16x32_bf16 v[192:195], v[80:83], v[212:215], 0
    ds_read_b64_tr_b16 v[222:223], v3 offset:528
    v_mfma_f32_16x16x32_bf16 v[196:199], v[96:99], v[212:215], 0
    s_waitcnt lgkmcnt(5)
    ds_read_b128 v[232:235], v242 offset:2048
    v_mfma_f32_16x16x32_bf16 v[12:15], v[224:227], v[236:239], v[12:15]
    v_mfma_f32_16x16x32_bf16 v[200:203], v[112:115], v[212:215], 0
    ds_read_b64_tr_b16 v[224:225], v3 offset:640
    v_mfma_f32_16x16x32_bf16 v[204:207], v[128:131], v[212:215], 0
    ds_read_b128 v[212:215], v249 offset:14336
    v_mfma_f32_16x16x32_bf16 v[144:147], v[20:23], v[208:211], v[144:147]
    ds_read_b64_tr_b16 v[226:227], v3 offset:656
    v_mfma_f32_16x16x32_bf16 v[148:151], v[36:39], v[208:211], v[148:151]
    s_waitcnt lgkmcnt(4)
    ds_read_b128 v[236:239], v243 offset:2048
    v_mfma_f32_16x16x32_bf16 v[12:15], v[216:219], v[228:231], v[12:15]
    ds_read_b64_tr_b16 v[216:217], v3 offset:768
    v_mfma_f32_16x16x32_bf16 v[152:155], v[52:55], v[208:211], v[152:155]
    ds_read_b64_tr_b16 v[218:219], v3 offset:784
    v_mfma_f32_16x16x32_bf16 v[156:159], v[68:71], v[208:211], v[156:159]
    ds_read_b128 v[228:231], v244 offset:2048
    v_mfma_f32_16x16x32_bf16 v[160:163], v[84:87], v[208:211], v[160:163]
    v_mfma_f32_16x16x32_bf16 v[164:167], v[100:103], v[208:211], v[164:167]
    s_waitcnt lgkmcnt(4)
    v_mfma_f32_16x16x32_bf16 v[12:15], v[220:223], v[232:235], v[12:15]
    ds_read_b64_tr_b16 v[220:221], v3 offset:896
    v_mfma_f32_16x16x32_bf16 v[168:171], v[116:119], v[208:211], v[168:171]
    ds_read_b64_tr_b16 v[222:223], v3 offset:912
    v_mfma_f32_16x16x32_bf16 v[172:175], v[132:135], v[208:211], v[172:175]
    ds_read_b128 v[208:211], v250 offset:14336
    v_mfma_f32_16x16x32_bf16 v[176:179], v[20:23], v[212:215], v[176:179]
    ds_read_b128 v[232:235], v245 offset:2048
    v_mfma_f32_16x16x32_bf16 v[180:183], v[36:39], v[212:215], v[180:183]
    s_waitcnt lgkmcnt(4)
    v_mfma_f32_16x16x32_bf16 v[12:15], v[224:227], v[236:239], v[12:15]
    ds_read_b64_tr_b16 v[224:225], v3 offset:1024
    v_mfma_f32_16x16x32_bf16 v[184:187], v[52:55], v[212:215], v[184:187]
    ds_read_b64_tr_b16 v[226:227], v3 offset:1040
    v_mfma_f32_16x16x32_bf16 v[188:191], v[68:71], v[212:215], v[188:191]
    ds_read_b128 v[236:239], v242 offset:2560
    v_mfma_f32_16x16x32_bf16 v[192:195], v[84:87], v[212:215], v[192:195]
    v_mfma_f32_16x16x32_bf16 v[12:15], v[216:219], v[228:231], v[12:15]
    v_mfma_f32_16x16x32_bf16 v[196:199], v[100:103], v[212:215], v[196:199]
    ds_read_b64_tr_b16 v[216:217], v3 offset:1152
    v_mfma_f32_16x16x32_bf16 v[200:203], v[116:119], v[212:215], v[200:203]
    ds_read_b64_tr_b16 v[218:219], v3 offset:1168
    v_mfma_f32_16x16x32_bf16 v[204:207], v[132:135], v[212:215], v[204:207]
    s_waitcnt lgkmcnt(3)
    ds_read_b128 v[212:215], v251 offset:14336
    v_mfma_f32_16x16x32_bf16 v[144:147], v[24:27], v[208:211], v[144:147]
    ds_read_b128 v[228:231], v243 offset:2560
    v_mfma_f32_16x16x32_bf16 v[12:15], v[220:223], v[232:235], v[12:15]
    v_mfma_f32_16x16x32_bf16 v[148:151], v[40:43], v[208:211], v[148:151]
    ds_read_b64_tr_b16 v[220:221], v3 offset:1280
    v_mfma_f32_16x16x32_bf16 v[152:155], v[56:59], v[208:211], v[152:155]
    ds_read_b64_tr_b16 v[222:223], v3 offset:1296
    v_mfma_f32_16x16x32_bf16 v[156:159], v[72:75], v[208:211], v[156:159]
    ds_read_b128 v[232:235], v244 offset:2560
    v_mfma_f32_16x16x32_bf16 v[160:163], v[88:91], v[208:211], v[160:163]
    s_waitcnt lgkmcnt(4)
    v_mfma_f32_16x16x32_bf16 v[12:15], v[224:227], v[236:239], v[12:15]
    v_mfma_f32_16x16x32_bf16 v[164:167], v[104:107], v[208:211], v[164:167]
    ds_read_b64_tr_b16 v[224:225], v3 offset:1408
    v_mfma_f32_16x16x32_bf16 v[168:171], v[120:123], v[208:211], v[168:171]
    ds_read_b64_tr_b16 v[226:227], v3 offset:1424
    v_mfma_f32_16x16x32_bf16 v[172:175], v[136:139], v[208:211], v[172:175]
    ds_read_b128 v[208:211], v252 offset:14336
    v_mfma_f32_16x16x32_bf16 v[176:179], v[24:27], v[212:215], v[176:179]
    s_waitcnt lgkmcnt(3)
    ds_read_b128 v[236:239], v245 offset:2560
    v_mfma_f32_16x16x32_bf16 v[12:15], v[216:219], v[228:231], v[12:15]
    ds_read_b64_tr_b16 v[216:217], v3 offset:1536
    v_mfma_f32_16x16x32_bf16 v[180:183], v[40:43], v[212:215], v[180:183]
    ds_read_b64_tr_b16 v[218:219], v3 offset:1552
    v_mfma_f32_16x16x32_bf16 v[184:187], v[56:59], v[212:215], v[184:187]
    ds_read_b128 v[228:231], v242 offset:3072
    v_mfma_f32_16x16x32_bf16 v[188:191], v[72:75], v[212:215], v[188:191]
    v_mfma_f32_16x16x32_bf16 v[192:195], v[88:91], v[212:215], v[192:195]
    v_mfma_f32_16x16x32_bf16 v[12:15], v[220:223], v[232:235], v[12:15]
    ds_read_b64_tr_b16 v[220:221], v3 offset:1664
    v_mfma_f32_16x16x32_bf16 v[196:199], v[104:107], v[212:215], v[196:199]
    ds_read_b64_tr_b16 v[222:223], v3 offset:1680
    v_mfma_f32_16x16x32_bf16 v[200:203], v[120:123], v[212:215], v[200:203]
    ds_read_b128 v[232:235], v243 offset:3072
    v_mfma_f32_16x16x32_bf16 v[204:207], v[136:139], v[212:215], v[204:207]
    s_waitcnt lgkmcnt(3)
    ds_read_b128 v[212:215], v253 offset:14336
    v_mfma_f32_16x16x32_bf16 v[144:147], v[28:31], v[208:211], v[144:147]
    v_mfma_f32_16x16x32_bf16 v[12:15], v[224:227], v[236:239], v[12:15]
    ds_read_b64_tr_b16 v[224:225], v3 offset:1792
    v_mfma_f32_16x16x32_bf16 v[148:151], v[44:47], v[208:211], v[148:151]
    ds_read_b64_tr_b16 v[226:227], v3 offset:1808
    v_mfma_f32_16x16x32_bf16 v[152:155], v[60:63], v[208:211], v[152:155]
    ds_read_b128 v[236:239], v244 offset:3072
    v_mfma_f32_16x16x32_bf16 v[156:159], v[76:79], v[208:211], v[156:159]
    v_mfma_f32_16x16x32_bf16 v[12:15], v[216:219], v[228:231], v[12:15]
    v_mfma_f32_16x16x32_bf16 v[160:163], v[92:95], v[208:211], v[160:163]
    ds_read_b64_tr_b16 v[216:217], v3 offset:1920
    v_mfma_f32_16x16x32_bf16 v[164:167], v[108:111], v[208:211], v[164:167]
    ds_read_b64_tr_b16 v[218:219], v3 offset:1936
    v_mfma_f32_16x16x32_bf16 v[168:171], v[124:127], v[208:211], v[168:171]
    ds_read_b128 v[228:231], v245 offset:3072
    v_mfma_f32_16x16x32_bf16 v[172:175], v[140:143], v[208:211], v[172:175]
    s_waitcnt lgkmcnt(3)
    ds_read_b128 v[208:211], v246 offset:12288
    v_mfma_f32_16x16x32_bf16 v[12:15], v[220:223], v[232:235], v[12:15]
    v_mfma_f32_16x16x32_bf16 v[176:179], v[28:31], v[212:215], v[176:179]
    ds_read_b64_tr_b16 v[220:221], v3 offset:2048
    v_mfma_f32_16x16x32_bf16 v[180:183], v[44:47], v[212:215], v[180:183]
    ds_read_b64_tr_b16 v[222:223], v3 offset:2064
    v_mfma_f32_16x16x32_bf16 v[184:187], v[60:63], v[212:215], v[184:187]
    ds_read_b128 v[232:235], v242 offset:3584
    v_mfma_f32_16x16x32_bf16 v[188:191], v[76:79], v[212:215], v[188:191]
    v_mfma_f32_16x16x32_bf16 v[12:15], v[224:227], v[236:239], v[12:15]
    v_mfma_f32_16x16x32_bf16 v[192:195], v[92:95], v[212:215], v[192:195]
    ds_read_b64_tr_b16 v[224:225], v3 offset:2176
    v_bfi_b32 v240, v5, 0, v179
    v_mfma_f32_16x16x32_bf16 v[196:199], v[108:111], v[212:215], v[196:199]
    ds_bpermute_b32 v240, v4, v240
    v_add_f32 v146, v146, v177
    v_mfma_f32_16x16x32_bf16 v[200:203], v[124:127], v[212:215], v[200:203]
    ds_read_b64_tr_b16 v[226:227], v3 offset:2192
    v_add_f32 v147, v147, v178
    v_mfma_f32_16x16x32_bf16 v[204:207], v[140:143], v[212:215], v[204:207]
    s_waitcnt lgkmcnt(3)
    ds_read_b128 v[212:215], v247 offset:12288
    v_add_f32 v145, v145, v176
    v_mfma_f32_16x16x32_bf16 v[12:15], v[216:219], v[228:231], v[12:15]
    ds_read_b128 v[236:239], v243 offset:3584
    v_cvt_pk_bf16_f32 v9, v146, v147
    v_mfma_f32_16x16x32_bf16 v[148:151], v[16:19], v[208:211], v[148:151]
    ds_read_b64_tr_b16 v[216:217], v3 offset:2304
    v_mfma_f32_16x16x32_bf16 v[152:155], v[32:35], v[208:211], v[152:155]
    s_waitcnt lgkmcnt(4)
    ds_read_b64_tr_b16 v[218:219], v3 offset:2320
    v_add_f32 v144, v144, v240
    v_mfma_f32_16x16x32_bf16 v[156:159], v[48:51], v[208:211], v[156:159]
    ds_read_b128 v[228:231], v244 offset:3584
    v_cvt_pk_bf16_f32 v8, v144, v145
    v_mfma_f32_16x16x32_bf16 v[160:163], v[64:67], v[208:211], v[160:163]
    v_mfma_f32_16x16x32_bf16 v[12:15], v[220:223], v[232:235], v[12:15]
    ds_read_b64_tr_b16 v[220:221], v3 offset:2432
    v_mfma_f32_16x16x32_bf16 v[164:167], v[80:83], v[208:211], v[164:167]
    ds_read_b64_tr_b16 v[222:223], v3 offset:2448
    v_mfma_f32_16x16x32_bf16 v[168:171], v[96:99], v[208:211], v[168:171]
    ds_read_b128 v[232:235], v245 offset:3584
    v_mfma_f32_16x16x32_bf16 v[172:175], v[112:115], v[208:211], v[172:175]
    s_waitcnt lgkmcnt(4)
    ds_read_b128 v[208:211], v248 offset:12288
    v_mfma_f32_16x16x32_bf16 v[180:183], v[16:19], v[212:215], v[180:183]
    v_mfma_f32_16x16x32_bf16 v[12:15], v[224:227], v[236:239], v[12:15]
    ds_read_b64_tr_b16 v[224:225], v3 offset:0
    v_mfma_f32_16x16x32_bf16 v[184:187], v[32:35], v[212:215], v[184:187]
    ds_read_b64_tr_b16 v[226:227], v3 offset:16
    v_mfma_f32_16x16x32_bf16 v[188:191], v[48:51], v[212:215], v[188:191]
    ds_read_b128 v[236:239], v242 offset:2048
    v_mfma_f32_16x16x32_bf16 v[192:195], v[64:67], v[212:215], v[192:195]
    s_waitcnt lgkmcnt(4)
    v_mfma_f32_16x16x32_bf16 v[12:15], v[216:219], v[228:231], v[12:15]
    v_mfma_f32_16x16x32_bf16 v[196:199], v[80:83], v[212:215], v[196:199]
    ds_read_b64_tr_b16 v[216:217], v3 offset:128
    v_mfma_f32_16x16x32_bf16 v[200:203], v[96:99], v[212:215], v[200:203]
    ds_read_b64_tr_b16 v[218:219], v3 offset:144
    v_mfma_f32_16x16x32_bf16 v[204:207], v[112:115], v[212:215], v[204:207]
    s_waitcnt lgkmcnt(3)
    ds_read_b128 v[212:215], v249 offset:12288
    v_mfma_f32_16x16x32_bf16 v[148:151], v[20:23], v[208:211], v[148:151]
    ds_read_b128 v[228:231], v243 offset:2048
    v_mfma_f32_16x16x32_bf16 v[12:15], v[220:223], v[232:235], v[12:15]
    v_mfma_f32_16x16x32_bf16 v[152:155], v[36:39], v[208:211], v[152:155]
    ds_read_b64_tr_b16 v[220:221], v3 offset:256
    v_mfma_f32_16x16x32_bf16 v[156:159], v[52:55], v[208:211], v[156:159]
    ds_read_b64_tr_b16 v[222:223], v3 offset:272
    v_mfma_f32_16x16x32_bf16 v[160:163], v[68:71], v[208:211], v[160:163]
    ds_read_b128 v[232:235], v244 offset:2048
    v_mfma_f32_16x16x32_bf16 v[164:167], v[84:87], v[208:211], v[164:167]
    s_waitcnt lgkmcnt(4)
    v_mfma_f32_16x16x32_bf16 v[140:143], v[224:227], v[236:239], 0
    v_mfma_f32_16x16x32_bf16 v[168:171], v[100:103], v[208:211], v[168:171]
    ds_read_b64_tr_b16 v[224:225], v3 offset:384
    v_mfma_f32_16x16x32_bf16 v[172:175], v[116:119], v[208:211], v[172:175]
    ds_read_b128 v[208:211], v250 offset:12288
    v_mfma_f32_16x16x32_bf16 v[180:183], v[20:23], v[212:215], v[180:183]
    ds_read_b64_tr_b16 v[226:227], v3 offset:400
    v_mfma_f32_16x16x32_bf16 v[184:187], v[36:39], v[212:215], v[184:187]
    s_waitcnt lgkmcnt(3)
    ds_read_b128 v[236:239], v245 offset:2048
    v_mfma_f32_16x16x32_bf16 v[140:143], v[216:219], v[228:231], v[140:143]
    ds_read_b64_tr_b16 v[216:217], v3 offset:512
    v_mfma_f32_16x16x32_bf16 v[188:191], v[52:55], v[212:215], v[188:191]
    ds_read_b64_tr_b16 v[218:219], v3 offset:528
    v_mfma_f32_16x16x32_bf16 v[192:195], v[68:71], v[212:215], v[192:195]
    ds_read_b128 v[228:231], v242 offset:2560
    v_mfma_f32_16x16x32_bf16 v[196:199], v[84:87], v[212:215], v[196:199]
    v_mfma_f32_16x16x32_bf16 v[200:203], v[100:103], v[212:215], v[200:203]
    v_mfma_f32_16x16x32_bf16 v[140:143], v[220:223], v[232:235], v[140:143]
    ds_read_b64_tr_b16 v[220:221], v3 offset:640
    v_mfma_f32_16x16x32_bf16 v[204:207], v[116:119], v[212:215], v[204:207]
    s_waitcnt lgkmcnt(3)
    ds_read_b128 v[212:215], v251 offset:12288
    v_mfma_f32_16x16x32_bf16 v[148:151], v[24:27], v[208:211], v[148:151]
    ds_read_b64_tr_b16 v[222:223], v3 offset:656
    v_mfma_f32_16x16x32_bf16 v[152:155], v[40:43], v[208:211], v[152:155]
    ds_read_b128 v[232:235], v243 offset:2560
    v_mfma_f32_16x16x32_bf16 v[156:159], v[56:59], v[208:211], v[156:159]
    v_mfma_f32_16x16x32_bf16 v[140:143], v[224:227], v[236:239], v[140:143]
    ds_read_b64_tr_b16 v[224:225], v3 offset:768
    v_mfma_f32_16x16x32_bf16 v[160:163], v[72:75], v[208:211], v[160:163]
    ds_read_b64_tr_b16 v[226:227], v3 offset:784
    v_mfma_f32_16x16x32_bf16 v[164:167], v[88:91], v[208:211], v[164:167]
    ds_read_b128 v[236:239], v244 offset:2560
    v_mfma_f32_16x16x32_bf16 v[168:171], v[104:107], v[208:211], v[168:171]
    s_waitcnt lgkmcnt(4)
    v_mfma_f32_16x16x32_bf16 v[140:143], v[216:219], v[228:231], v[140:143]
    v_mfma_f32_16x16x32_bf16 v[172:175], v[120:123], v[208:211], v[172:175]
    ds_read_b128 v[208:211], v252 offset:12288
    v_mfma_f32_16x16x32_bf16 v[180:183], v[24:27], v[212:215], v[180:183]
    ds_read_b64_tr_b16 v[216:217], v3 offset:896
    v_mfma_f32_16x16x32_bf16 v[184:187], v[40:43], v[212:215], v[184:187]
    ds_read_b64_tr_b16 v[218:219], v3 offset:912
    v_mfma_f32_16x16x32_bf16 v[188:191], v[56:59], v[212:215], v[188:191]
    s_waitcnt lgkmcnt(3)
    ds_read_b128 v[228:231], v245 offset:2560
    v_mfma_f32_16x16x32_bf16 v[140:143], v[220:223], v[232:235], v[140:143]
    v_mfma_f32_16x16x32_bf16 v[192:195], v[72:75], v[212:215], v[192:195]
    ds_read_b64_tr_b16 v[220:221], v3 offset:1024
    v_mfma_f32_16x16x32_bf16 v[196:199], v[88:91], v[212:215], v[196:199]
    ds_read_b64_tr_b16 v[222:223], v3 offset:1040
    v_mfma_f32_16x16x32_bf16 v[200:203], v[104:107], v[212:215], v[200:203]
    ds_read_b128 v[232:235], v242 offset:3072
    v_mfma_f32_16x16x32_bf16 v[204:207], v[120:123], v[212:215], v[204:207]
    ds_read_b128 v[212:215], v253 offset:12288
    v_mfma_f32_16x16x32_bf16 v[140:143], v[224:227], v[236:239], v[140:143]
    s_waitcnt lgkmcnt(4)
    v_mfma_f32_16x16x32_bf16 v[148:151], v[28:31], v[208:211], v[148:151]
    ds_read_b64_tr_b16 v[224:225], v3 offset:1152
    v_mfma_f32_16x16x32_bf16 v[152:155], v[44:47], v[208:211], v[152:155]
    ds_read_b64_tr_b16 v[226:227], v3 offset:1168
    v_mfma_f32_16x16x32_bf16 v[156:159], v[60:63], v[208:211], v[156:159]
    ds_read_b128 v[236:239], v243 offset:3072
    v_mfma_f32_16x16x32_bf16 v[160:163], v[76:79], v[208:211], v[160:163]
    v_mfma_f32_16x16x32_bf16 v[140:143], v[216:219], v[228:231], v[140:143]
    ds_read_b64_tr_b16 v[216:217], v3 offset:1280
    v_mfma_f32_16x16x32_bf16 v[164:167], v[92:95], v[208:211], v[164:167]
    ds_read_b64_tr_b16 v[218:219], v3 offset:1296
    v_mfma_f32_16x16x32_bf16 v[168:171], v[108:111], v[208:211], v[168:171]
    ds_read_b128 v[228:231], v244 offset:3072
    v_mfma_f32_16x16x32_bf16 v[172:175], v[124:127], v[208:211], v[172:175]
    s_waitcnt lgkmcnt(4)
    ds_read_b128 v[208:211], v246 offset:10240
    v_mfma_f32_16x16x32_bf16 v[180:183], v[28:31], v[212:215], v[180:183]
    v_mfma_f32_16x16x32_bf16 v[140:143], v[220:223], v[232:235], v[140:143]
    ds_read_b64_tr_b16 v[220:221], v3 offset:1408
    v_mfma_f32_16x16x32_bf16 v[184:187], v[44:47], v[212:215], v[184:187]
    ds_read_b64_tr_b16 v[222:223], v3 offset:1424
    v_mfma_f32_16x16x32_bf16 v[188:191], v[60:63], v[212:215], v[188:191]
    ds_read_b128 v[232:235], v245 offset:3072
    v_mfma_f32_16x16x32_bf16 v[192:195], v[76:79], v[212:215], v[192:195]
    v_mfma_f32_16x16x32_bf16 v[196:199], v[92:95], v[212:215], v[196:199]
    s_waitcnt lgkmcnt(3)
    v_bfi_b32 v241, v5, v179, v183
    v_add_f32 v150, v150, v181
    v_mfma_f32_16x16x32_bf16 v[140:143], v[224:227], v[236:239], v[140:143]
    ds_bpermute_b32 v241, v4, v241
    v_add_f32 v151, v151, v182
    v_mfma_f32_16x16x32_bf16 v[200:203], v[108:111], v[212:215], v[200:203]
    ds_read_b64_tr_b16 v[224:225], v3 offset:1536
    v_add_f32 v149, v149, v180
    v_mfma_f32_16x16x32_bf16 v[204:207], v[124:127], v[212:215], v[204:207]
    ds_read_b128 v[212:215], v247 offset:10240
    v_cvt_pk_bf16_f32 v11, v150, v151
    v_mfma_f32_16x16x32_bf16 v[152:155], v[16:19], v[208:211], v[152:155]
    ds_read_b64_tr_b16 v[226:227], v3 offset:1552
    v_mfma_f32_16x16x32_bf16 v[140:143], v[216:219], v[228:231], v[140:143]
    ds_read_b128 v[236:239], v242 offset:3584
    v_mfma_f32_16x16x32_bf16 v[156:159], v[32:35], v[208:211], v[156:159]
    s_waitcnt lgkmcnt(4)
    ds_read_b64_tr_b16 v[216:217], v3 offset:1664
    v_add_f32 v148, v148, v241
    v_mfma_f32_16x16x32_bf16 v[160:163], v[48:51], v[208:211], v[160:163]
    ds_read_b64_tr_b16 v[218:219], v3 offset:1680
    v_cvt_pk_bf16_f32 v10, v148, v149
    v_mfma_f32_16x16x32_bf16 v[164:167], v[64:67], v[208:211], v[164:167]
    ds_read_b128 v[228:231], v243 offset:3584
    v_permlane16_swap_b32 v9, v11
    v_mfma_f32_16x16x32_bf16 v[168:171], v[80:83], v[208:211], v[168:171]
    v_mfma_f32_16x16x32_bf16 v[140:143], v[220:223], v[232:235], v[140:143]
    v_permlane16_swap_b32 v8, v10
    v_mfma_f32_16x16x32_bf16 v[172:175], v[96:99], v[208:211], v[172:175]
    s_waitcnt lgkmcnt(3)
    buffer_store_dwordx4 v[8:11], v6, s[36:39], s52 offen sc1
    v_mfma_f32_16x16x32_bf16 v[184:187], v[16:19], v[212:215], v[184:187]
    ds_read_b128 v[208:211], v248 offset:10240
    v_mfma_f32_16x16x32_bf16 v[188:191], v[32:35], v[212:215], v[188:191]
    ds_read_b64_tr_b16 v[220:221], v3 offset:1792
    v_mfma_f32_16x16x32_bf16 v[192:195], v[48:51], v[212:215], v[192:195]
    ds_read_b64_tr_b16 v[222:223], v3 offset:1808
    v_mfma_f32_16x16x32_bf16 v[140:143], v[224:227], v[236:239], v[140:143]
    ds_read_b128 v[232:235], v244 offset:3584
    v_mfma_f32_16x16x32_bf16 v[196:199], v[64:67], v[212:215], v[196:199]
    ds_read_b64_tr_b16 v[224:225], v3 offset:1920
    v_mfma_f32_16x16x32_bf16 v[200:203], v[80:83], v[212:215], v[200:203]
    ds_read_b64_tr_b16 v[226:227], v3 offset:1936
    s_branch L_mt_s
T_mt_s:
    s_setpc_b64 s[0:1]
L_mt_s:
    v_mfma_f32_16x16x32_bf16 v[204:207], v[96:99], v[212:215], v[204:207]
    s_waitcnt lgkmcnt(5)
    ds_read_b128 v[212:215], v249 offset:10240
    v_mfma_f32_16x16x32_bf16 v[152:155], v[20:23], v[208:211], v[152:155]
    ds_read_b128 v[236:239], v245 offset:3584
    v_mfma_f32_16x16x32_bf16 v[140:143], v[216:219], v[228:231], v[140:143]
    v_mfma_f32_16x16x32_bf16 v[156:159], v[36:39], v[208:211], v[156:159]
    v_mfma_f32_16x16x32_bf16 v[160:163], v[52:55], v[208:211], v[160:163]
    v_mfma_f32_16x16x32_bf16 v[164:167], v[68:71], v[208:211], v[164:167]
    v_mfma_f32_16x16x32_bf16 v[168:171], v[84:87], v[208:211], v[168:171]
    s_waitcnt lgkmcnt(1)
    v_mfma_f32_16x16x32_bf16 v[140:143], v[220:223], v[232:235], v[140:143]
    v_mfma_f32_16x16x32_bf16 v[172:175], v[100:103], v[208:211], v[172:175]
    ds_read_b128 v[208:211], v250 offset:10240
    v_mfma_f32_16x16x32_bf16 v[184:187], v[20:23], v[212:215], v[184:187]
    v_mfma_f32_16x16x32_bf16 v[188:191], v[36:39], v[212:215], v[188:191]
    v_mfma_f32_16x16x32_bf16 v[192:195], v[52:55], v[212:215], v[192:195]
    s_waitcnt lgkmcnt(1)
    v_mfma_f32_16x16x32_bf16 v[140:143], v[224:227], v[236:239], v[140:143]
    v_mov_b32 v136, s99
    v_mov_b32 v137, 1
    v_mfma_f32_16x16x32_bf16 v[196:199], v[68:71], v[212:215], v[196:199]
    v_mov_b32 v138, s62
    v_mfma_f32_16x16x32_bf16 v[200:203], v[84:87], v[212:215], v[200:203]
    v_mfma_f32_16x16x32_bf16 v[204:207], v[100:103], v[212:215], v[204:207]
    s_waitcnt lgkmcnt(0)
    ds_read_b128 v[212:215], v251 offset:10240
    v_bfi_b32 v128, v138, v140, v12
    v_mfma_f32_16x16x32_bf16 v[152:155], v[24:27], v[208:211], v[152:155]
    v_bfi_b32 v129, v138, v141, v13
    v_bfi_b32 v130, v138, v142, v14
    v_mfma_f32_16x16x32_bf16 v[156:159], v[40:43], v[208:211], v[156:159]
    v_bfi_b32 v131, v138, v143, v15
    v_mfma_f32_16x16x32_bf16 v[160:163], v[56:59], v[208:211], v[160:163]
    ds_write_b128 v7, v[128:131]
    v_mfma_f32_16x16x32_bf16 v[164:167], v[72:75], v[208:211], v[164:167]
    s_mov_b64 exec, 1
    ds_add_u32 v136, v137
    s_mov_b64 exec, -1
    v_mfma_f32_16x16x32_bf16 v[168:171], v[88:91], v[208:211], v[168:171]
    v_bfi_b32 v132, v138, v12, v140
    v_bfi_b32 v133, v138, v13, v141
    v_mfma_f32_16x16x32_bf16 v[172:175], v[104:107], v[208:211], v[172:175]
    s_waitcnt lgkmcnt(2)
    ds_read_b128 v[208:211], v252 offset:10240
    v_bfi_b32 v134, v138, v14, v142
    v_mfma_f32_16x16x32_bf16 v[184:187], v[24:27], v[212:215], v[184:187]
    v_bfi_b32 v135, v138, v15, v143
    v_mfma_f32_16x16x32_bf16 v[188:191], v[40:43], v[212:215], v[188:191]
    ds_read_b32 v137, v136
    v_mfma_f32_16x16x32_bf16 v[192:195], v[56:59], v[212:215], v[192:195]
    ds_read_b128 v[216:219], v254
    v_mfma_f32_16x16x32_bf16 v[196:199], v[72:75], v[212:215], v[196:199]
    v_mfma_f32_16x16x32_bf16 v[200:203], v[88:91], v[212:215], v[200:203]
    v_mfma_f32_16x16x32_bf16 v[204:207], v[104:107], v[212:215], v[204:207]
    s_waitcnt lgkmcnt(2)
    ds_read_b128 v[212:215], v253 offset:10240
    v_mfma_f32_16x16x32_bf16 v[152:155], v[28:31], v[208:211], v[152:155]
    v_mfma_f32_16x16x32_bf16 v[156:159], v[44:47], v[208:211], v[156:159]
    s_waitcnt lgkmcnt(1)
    v_readfirstlane_b32 s60, v137
    s_cmp_lt_u32 s60, 2
    s_cbranch_scc1 L_zspin_s
L_zback_s:
    v_add_f32 v132, v132, v216
    v_mfma_f32_16x16x32_bf16 v[160:163], v[60:63], v[208:211], v[160:163]
    v_add_f32 v133, v133, v217
    v_add_f32 v134, v134, v218
    v_mfma_f32_16x16x32_bf16 v[164:167], v[76:79], v[208:211], v[164:167]
    v_add_f32 v135, v135, v219
    v_cvt_pk_bf16_f32 v138, v132, v133
    v_mfma_f32_16x16x32_bf16 v[168:171], v[92:95], v[208:211], v[168:171]
    v_cvt_pk_bf16_f32 v139, v134, v135
    v_mfma_f32_16x16x32_bf16 v[172:175], v[108:111], v[208:211], v[172:175]
    s_waitcnt lgkmcnt(0)
    ds_read_b128 v[208:211], v246 offset:8192
    v_mfma_f32_16x16x32_bf16 v[184:187], v[28:31], v[212:215], v[184:187]
    buffer_store_dwordx2 v[138:139], v255, s[48:51], s98 offen sc1
    v_mfma_f32_16x16x32_bf16 v[188:191], v[44:47], v[212:215], v[188:191]
    v_mfma_f32_16x16x32_bf16 v[192:195], v[60:63], v[212:215], v[192:195]
    ds_read_b128 v[216:219], v248 offset:8192
    v_mfma_f32_16x16x32_bf16 v[196:199], v[76:79], v[212:215], v[196:199]
    v_mfma_f32_16x16x32_bf16 v[200:203], v[92:95], v[212:215], v[200:203]
    v_mfma_f32_16x16x32_bf16 v[204:207], v[108:111], v[212:215], v[204:207]
    s_waitcnt lgkmcnt(1)
    ds_read_b128 v[212:215], v247 offset:8192
    v_bfi_b32 v0, v5, v183, v187
    v_mfma_f32_16x16x32_bf16 v[156:159], v[16:19], v[208:211], v[156:159]
    ds_bpermute_b32 v0, v4, v0
    v_add_f32 v154, v154, v185
    v_mfma_f32_16x16x32_bf16 v[160:163], v[32:35], v[208:211], v[160:163]
    ds_read_b128 v[220:223], v249 offset:8192
    v_add_f32 v155, v155, v186
    v_mfma_f32_16x16x32_bf16 v[164:167], v[48:51], v[208:211], v[164:167]
    v_add_f32 v153, v153, v184
    v_cvt_pk_bf16_f32 v9, v154, v155
    v_mfma_f32_16x16x32_bf16 v[168:171], v[64:67], v[208:211], v[168:171]
    v_mfma_f32_16x16x32_bf16 v[172:175], v[80:83], v[208:211], v[172:175]
    s_waitcnt lgkmcnt(2)
    v_mfma_f32_16x16x32_bf16 v[188:191], v[16:19], v[212:215], v[188:191]
    s_waitcnt lgkmcnt(1)
    v_add_f32 v152, v152, v0
    v_cvt_pk_bf16_f32 v8, v152, v153
    v_mfma_f32_16x16x32_bf16 v[192:195], v[32:35], v[212:215], v[192:195]
    ds_read_b128 v[224:227], v250 offset:8192
    v_mfma_f32_16x16x32_bf16 v[196:199], v[48:51], v[212:215], v[196:199]
    v_mfma_f32_16x16x32_bf16 v[200:203], v[64:67], v[212:215], v[200:203]
    v_mfma_f32_16x16x32_bf16 v[204:207], v[80:83], v[212:215], v[204:207]
    v_mfma_f32_16x16x32_bf16 v[156:159], v[20:23], v[216:219], v[156:159]
    v_mfma_f32_16x16x32_bf16 v[160:163], v[36:39], v[216:219], v[160:163]
    v_mov_b32 v136, 1
    s_waitcnt vmcnt(0)
    buffer_store_dword v136, off, s[40:43], s97 offset:1024 sc1
    v_mfma_f32_16x16x32_bf16 v[164:167], v[52:55], v[216:219], v[164:167]
    ds_read_b128 v[228:231], v251 offset:8192
    v_mfma_f32_16x16x32_bf16 v[168:171], v[68:71], v[216:219], v[168:171]
    v_mfma_f32_16x16x32_bf16 v[172:175], v[84:87], v[216:219], v[172:175]
    s_waitcnt lgkmcnt(1)
    v_mfma_f32_16x16x32_bf16 v[188:191], v[20:23], v[220:223], v[188:191]
    v_mfma_f32_16x16x32_bf16 v[192:195], v[36:39], v[220:223], v[192:195]
    ds_read_b128 v[232:235], v252 offset:8192
    v_mfma_f32_16x16x32_bf16 v[196:199], v[52:55], v[220:223], v[196:199]
    v_mfma_f32_16x16x32_bf16 v[200:203], v[68:71], v[220:223], v[200:203]
    v_mfma_f32_16x16x32_bf16 v[204:207], v[84:87], v[220:223], v[204:207]
    v_mfma_f32_16x16x32_bf16 v[156:159], v[24:27], v[224:227], v[156:159]
    v_mfma_f32_16x16x32_bf16 v[160:163], v[40:43], v[224:227], v[160:163]
    ds_read_b128 v[236:239], v253 offset:8192
    v_mfma_f32_16x16x32_bf16 v[164:167], v[56:59], v[224:227], v[164:167]
    v_mfma_f32_16x16x32_bf16 v[168:171], v[72:75], v[224:227], v[168:171]
    v_mfma_f32_16x16x32_bf16 v[172:175], v[88:91], v[224:227], v[172:175]
    s_waitcnt lgkmcnt(1)
    ds_read_b32 v2, v1
    v_mfma_f32_16x16x32_bf16 v[188:191], v[24:27], v[228:231], v[188:191]
    v_mfma_f32_16x16x32_bf16 v[192:195], v[40:43], v[228:231], v[192:195]
    v_mfma_f32_16x16x32_bf16 v[196:199], v[56:59], v[228:231], v[196:199]
    v_mfma_f32_16x16x32_bf16 v[200:203], v[72:75], v[228:231], v[200:203]
    v_mfma_f32_16x16x32_bf16 v[204:207], v[88:91], v[228:231], v[204:207]
    v_mfma_f32_16x16x32_bf16 v[156:159], v[28:31], v[232:235], v[156:159]
    v_mfma_f32_16x16x32_bf16 v[160:163], v[44:47], v[232:235], v[160:163]
    s_waitcnt lgkmcnt(0)
    v_readfirstlane_b32 s60, v2
    s_cmp_lt_u32 s60, 4
    s_cbranch_scc1 L_mspin_s
L_mback_s:
    v_mfma_f32_16x16x32_bf16 v[164:167], v[60:63], v[232:235], v[164:167]
    ds_read_b128 v[208:211], v246 offset:6144
    v_mfma_f32_16x16x32_bf16 v[168:171], v[76:79], v[232:235], v[168:171]
    ds_read_b128 v[212:215], v247 offset:6144
    v_mfma_f32_16x16x32_bf16 v[172:175], v[92:95], v[232:235], v[172:175]
    ds_read_b128 v[216:219], v248 offset:6144
    v_mfma_f32_16x16x32_bf16 v[188:191], v[28:31], v[236:239], v[188:191]
    v_mfma_f32_16x16x32_bf16 v[192:195], v[44:47], v[236:239], v[192:195]
    v_mfma_f32_16x16x32_bf16 v[196:199], v[60:63], v[236:239], v[196:199]
    v_mfma_f32_16x16x32_bf16 v[200:203], v[76:79], v[236:239], v[200:203]
    ds_read_b128 v[220:223], v249 offset:6144
    v_mfma_f32_16x16x32_bf16 v[204:207], v[92:95], v[236:239], v[204:207]
    s_waitcnt lgkmcnt(2)
    v_mfma_f32_16x16x32_bf16 v[160:163], v[16:19], v[208:211], v[160:163]
    v_mfma_f32_16x16x32_bf16 v[164:167], v[32:35], v[208:211], v[164:167]
    v_bfi_b32 v240, v5, v187, v191
    v_add_f32 v158, v158, v189
    v_mfma_f32_16x16x32_bf16 v[168:171], v[48:51], v[208:211], v[168:171]
    ds_bpermute_b32 v240, v4, v240
    v_add_f32 v159, v159, v190
    v_mfma_f32_16x16x32_bf16 v[172:175], v[64:67], v[208:211], v[172:175]
    ds_read_b128 v[224:227], v250 offset:6144
    v_add_f32 v157, v157, v188
    v_mfma_f32_16x16x32_bf16 v[192:195], v[16:19], v[212:215], v[192:195]
    v_cvt_pk_bf16_f32 v11, v158, v159
    v_mfma_f32_16x16x32_bf16 v[196:199], v[32:35], v[212:215], v[196:199]
    v_mfma_f32_16x16x32_bf16 v[200:203], v[48:51], v[212:215], v[200:203]
    ds_read_b128 v[228:231], v251 offset:6144
    v_mfma_f32_16x16x32_bf16 v[204:207], v[64:67], v[212:215], v[204:207]
    s_waitcnt lgkmcnt(3)
    s_waitcnt lgkmcnt(2)
    v_add_f32 v156, v156, v240
    v_cvt_pk_bf16_f32 v10, v156, v157
    v_mfma_f32_16x16x32_bf16 v[160:163], v[20:23], v[216:219], v[160:163]
    v_permlane16_swap_b32 v9, v11
    v_mfma_f32_16x16x32_bf16 v[164:167], v[36:39], v[216:219], v[164:167]
    v_mfma_f32_16x16x32_bf16 v[168:171], v[52:55], v[216:219], v[168:171]
    ds_read_b128 v[232:235], v252 offset:6144
    v_permlane16_swap_b32 v8, v10
    v_mfma_f32_16x16x32_bf16 v[172:175], v[68:71], v[216:219], v[172:175]
    buffer_store_dwordx4 v[8:11], v6, s[36:39], s53 offen sc1
    v_mfma_f32_16x16x32_bf16 v[192:195], v[20:23], v[220:223], v[192:195]
    ds_read_b128 v[80:83], v246 offset:2048
    v_mfma_f32_16x16x32_bf16 v[196:199], v[36:39], v[220:223], v[196:199]
    v_mfma_f32_16x16x32_bf16 v[200:203], v[52:55], v[220:223], v[200:203]
    ds_read_b128 v[236:239], v253 offset:6144
    v_mfma_f32_16x16x32_bf16 v[204:207], v[68:71], v[220:223], v[204:207]
    s_waitcnt lgkmcnt(3)
    ds_read_b128 v[84:87], v247 offset:2048
    v_mfma_f32_16x16x32_bf16 v[160:163], v[24:27], v[224:227], v[160:163]
    ds_read_b128 v[88:91], v248 offset:2048
    v_mfma_f32_16x16x32_bf16 v[164:167], v[40:43], v[224:227], v[164:167]
    v_mfma_f32_16x16x32_bf16 v[168:171], v[56:59], v[224:227], v[168:171]
    ds_read_b128 v[208:211], v246 offset:4096
    v_mfma_f32_16x16x32_bf16 v[172:175], v[72:75], v[224:227], v[172:175]
    ds_read_b128 v[92:95], v249 offset:2048
    v_mfma_f32_16x16x32_bf16 v[192:195], v[24:27], v[228:231], v[192:195]
    ds_read_b128 v[96:99], v250 offset:2048
    v_mfma_f32_16x16x32_bf16 v[196:199], v[40:43], v[228:231], v[196:199]
    ds_read_b128 v[212:215], v247 offset:4096
    v_mfma_f32_16x16x32_bf16 v[200:203], v[56:59], v[228:231], v[200:203]
    ds_read_b128 v[100:103], v251 offset:2048
    v_mfma_f32_16x16x32_bf16 v[204:207], v[72:75], v[228:231], v[204:207]
    s_waitcnt lgkmcnt(5)
    v_mfma_f32_16x16x32_bf16 v[160:163], v[28:31], v[232:235], v[160:163]
    ds_read_b128 v[216:219], v248 offset:4096
    v_mfma_f32_16x16x32_bf16 v[164:167], v[44:47], v[232:235], v[164:167]
    ds_read_b128 v[104:107], v252 offset:2048
    v_mfma_f32_16x16x32_bf16 v[168:171], v[60:63], v[232:235], v[168:171]
    ds_read_b128 v[108:111], v253 offset:2048
    v_mfma_f32_16x16x32_bf16 v[172:175], v[76:79], v[232:235], v[172:175]
    ds_read_b128 v[220:223], v249 offset:4096
    v_mfma_f32_16x16x32_bf16 v[192:195], v[28:31], v[236:239], v[192:195]
    ds_read_b128 v[112:115], v246 offset:0
    v_mfma_f32_16x16x32_bf16 v[196:199], v[44:47], v[236:239], v[196:199]
    v_mfma_f32_16x16x32_bf16 v[200:203], v[60:63], v[236:239], v[200:203]
    ds_read_b128 v[224:227], v250 offset:4096
    v_mfma_f32_16x16x32_bf16 v[204:207], v[76:79], v[236:239], v[204:207]
    s_waitcnt lgkmcnt(4)
    ds_read_b128 v[116:119], v247 offset:0
    v_mfma_f32_16x16x32_bf16 v[164:167], v[16:19], v[208:211], v[164:167]
    ds_read_b128 v[120:123], v248 offset:0
    v_bfi_b32 v241, v5, v191, v195
    v_mfma_f32_16x16x32_bf16 v[168:171], v[32:35], v[208:211], v[168:171]
    ds_bpermute_b32 v241, v4, v241
    v_add_f32 v162, v162, v193
    v_mfma_f32_16x16x32_bf16 v[172:175], v[48:51], v[208:211], v[172:175]
    ds_read_b128 v[228:231], v251 offset:4096
    v_add_f32 v163, v163, v194
    v_mfma_f32_16x16x32_bf16 v[196:199], v[16:19], v[212:215], v[196:199]
    ds_read_b128 v[124:127], v249 offset:0
    v_add_f32 v161, v161, v192
    v_mfma_f32_16x16x32_bf16 v[200:203], v[32:35], v[212:215], v[200:203]
    ds_read_b128 v[232:235], v252 offset:4096
    v_cvt_pk_bf16_f32 v9, v162, v163
    v_mfma_f32_16x16x32_bf16 v[204:207], v[48:51], v[212:215], v[204:207]
    ds_read_b128 v[128:131], v250 offset:0
    v_mfma_f32_16x16x32_bf16 v[164:167], v[20:23], v[216:219], v[164:167]
    s_waitcnt lgkmcnt(4)
    ds_read_b128 v[132:135], v251 offset:0
    v_add_f32 v160, v160, v241
    v_mfma_f32_16x16x32_bf16 v[168:171], v[36:39], v[216:219], v[168:171]
    ds_read_b128 v[236:239], v253 offset:4096
    v_cvt_pk_bf16_f32 v8, v160, v161
    v_mfma_f32_16x16x32_bf16 v[172:175], v[52:55], v[216:219], v[172:175]
    ds_read_b128 v[136:139], v252 offset:0
    v_mfma_f32_16x16x32_bf16 v[196:199], v[20:23], v[220:223], v[196:199]
    v_mfma_f32_16x16x32_bf16 v[200:203], v[36:39], v[220:223], v[200:203]
    ds_read_b128 v[140:143], v253 offset:0
    v_mfma_f32_16x16x32_bf16 v[204:207], v[52:55], v[220:223], v[204:207]
    v_mfma_f32_16x16x32_bf16 v[164:167], v[24:27], v[224:227], v[164:167]
    v_mfma_f32_16x16x32_bf16 v[168:171], v[40:43], v[224:227], v[168:171]
    v_mfma_f32_16x16x32_bf16 v[172:175], v[56:59], v[224:227], v[172:175]
    s_waitcnt lgkmcnt(1)
    v_mfma_f32_16x16x32_bf16 v[196:199], v[24:27], v[228:231], v[196:199]
    v_mfma_f32_16x16x32_bf16 v[200:203], v[40:43], v[228:231], v[200:203]
    v_mfma_f32_16x16x32_bf16 v[204:207], v[56:59], v[228:231], v[204:207]
    v_mfma_f32_16x16x32_bf16 v[164:167], v[28:31], v[232:235], v[164:167]
    v_mfma_f32_16x16x32_bf16 v[168:171], v[44:47], v[232:235], v[168:171]
    v_mfma_f32_16x16x32_bf16 v[172:175], v[60:63], v[232:235], v[172:175]
    v_mfma_f32_16x16x32_bf16 v[196:199], v[28:31], v[236:239], v[196:199]
    v_mfma_f32_16x16x32_bf16 v[200:203], v[44:47], v[236:239], v[200:203]
    v_mfma_f32_16x16x32_bf16 v[204:207], v[60:63], v[236:239], v[204:207]
    v_mfma_f32_16x16x32_bf16 v[200:203], v[16:19], v[84:87], v[200:203]
    v_mfma_f32_16x16x32_bf16 v[200:203], v[20:23], v[92:95], v[200:203]
    v_mfma_f32_16x16x32_bf16 v[200:203], v[24:27], v[100:103], v[200:203]
    v_mfma_f32_16x16x32_bf16 v[200:203], v[28:31], v[108:111], v[200:203]
    v_mfma_f32_16x16x32_bf16 v[168:171], v[16:19], v[80:83], v[168:171]
    v_mfma_f32_16x16x32_bf16 v[168:171], v[20:23], v[88:91], v[168:171]
    v_bfi_b32 v0, v5, v195, v199
    v_add_f32 v166, v166, v197
    v_mfma_f32_16x16x32_bf16 v[168:171], v[24:27], v[96:99], v[168:171]
    ds_bpermute_b32 v0, v4, v0
    v_add_f32 v167, v167, v198
    v_mfma_f32_16x16x32_bf16 v[168:171], v[28:31], v[104:107], v[168:171]
    v_bfi_b32 v240, v5, v199, v203
    v_add_f32 v165, v165, v196
    v_mfma_f32_16x16x32_bf16 v[204:207], v[32:35], v[84:87], v[204:207]
    ds_bpermute_b32 v240, v4, v240
    v_cvt_pk_bf16_f32 v11, v166, v167
    v_mfma_f32_16x16x32_bf16 v[204:207], v[36:39], v[92:95], v[204:207]
    v_mfma_f32_16x16x32_bf16 v[204:207], v[40:43], v[100:103], v[204:207]
    v_mfma_f32_16x16x32_bf16 v[204:207], v[44:47], v[108:111], v[204:207]
    s_waitcnt lgkmcnt(1)
    v_add_f32 v164, v164, v0
    v_cvt_pk_bf16_f32 v10, v164, v165
    v_mfma_f32_16x16x32_bf16 v[204:207], v[16:19], v[116:119], v[204:207]
    v_permlane16_swap_b32 v9, v11
    v_mfma_f32_16x16x32_bf16 v[204:207], v[20:23], v[124:127], v[204:207]
    v_mfma_f32_16x16x32_bf16 v[204:207], v[24:27], v[132:135], v[204:207]
    v_permlane16_swap_b32 v8, v10
    v_mfma_f32_16x16x32_bf16 v[204:207], v[28:31], v[140:143], v[204:207]
    buffer_store_dwordx4 v[8:11], v6, s[36:39], s54 offen sc1
    v_add_f32 v170, v170, v201
    v_mfma_f32_16x16x32_bf16 v[172:175], v[32:35], v[80:83], v[172:175]
    v_add_f32 v171, v171, v202
    v_add_f32 v169, v169, v200
    v_mfma_f32_16x16x32_bf16 v[172:175], v[36:39], v[88:91], v[172:175]
    v_cvt_pk_bf16_f32 v9, v170, v171
    v_mfma_f32_16x16x32_bf16 v[172:175], v[40:43], v[96:99], v[172:175]
    s_waitcnt lgkmcnt(0)
    v_bfi_b32 v241, v5, v203, v207
    v_add_f32 v168, v168, v240
    v_mfma_f32_16x16x32_bf16 v[172:175], v[44:47], v[104:107], v[172:175]
    ds_bpermute_b32 v241, v4, v241
    v_cvt_pk_bf16_f32 v8, v168, v169
    v_mfma_f32_16x16x32_bf16 v[172:175], v[16:19], v[112:115], v[172:175]
    v_mfma_f32_16x16x32_bf16 v[172:175], v[20:23], v[120:123], v[172:175]
    v_mfma_f32_16x16x32_bf16 v[172:175], v[24:27], v[128:131], v[172:175]
    v_mfma_f32_16x16x32_bf16 v[172:175], v[28:31], v[136:139], v[172:175]
    s_nop 7
    v_add_f32 v174, v174, v205
    v_add_f32 v175, v175, v206
    v_add_f32 v173, v173, v204
    v_cvt_pk_bf16_f32 v11, v174, v175
    s_waitcnt lgkmcnt(0)
    v_add_f32 v172, v172, v241
    v_cvt_pk_bf16_f32 v10, v172, v173
    v_permlane16_swap_b32 v9, v11
    s_nop 0
    v_permlane16_swap_b32 v8, v10
    buffer_store_dwordx4 v[8:11], v6, s[36:39], s55 offen sc1
    v_mov_b32 v0, 2
    s_waitcnt vmcnt(0)
    buffer_store_dword v0, off, s[40:43], s97 offset:512 sc1
    s_endpgm
L_mspin_s:
    v_mov_b32 v1, 141404
    s_mov_b32 s85, 2097152
L_mwx1_s:
    ds_read_b32 v2, v1
    s_sub_u32 s85, s85, 1
    s_cbranch_scc1 L_end
    s_waitcnt lgkmcnt(0)
    v_readfirstlane_b32 s60, v2
    s_and_b32 s61, s60, 0xff
    s_cmp_ge_u32 s61, 4
    s_cbranch_scc0 L_mwx1_s
    s_branch L_mback_s
L_zspin_s:
    s_mov_b32 s85, 2097152
L_zs2_s:
    ds_read_b32 v137, v136
    ds_read_b128 v[216:219], v254
    s_sub_u32 s85, s85, 1
    s_cbranch_scc1 L_end
    s_waitcnt lgkmcnt(0)
    v_readfirstlane_b32 s60, v137
    s_cmp_lt_u32 s60, 2
    s_cbranch_scc1 L_zs2_s
    s_branch L_zback_s
.section .rodata,"a"
.p2align 6
.amdhsa_kernel concat_heads__ssm_conv_h3__ssm_conv_h3__prompt_kernel
  .amdhsa_next_free_vgpr 256
  .amdhsa_next_free_sgpr 102
  .amdhsa_accum_offset 256
  .amdhsa_group_segment_fixed_size 0
  .amdhsa_kernarg_size 120
  .amdhsa_user_sgpr_count 2
  .amdhsa_user_sgpr_kernarg_segment_ptr 1
  .amdhsa_system_sgpr_workgroup_id_x 1
  .amdhsa_float_denorm_mode_32 3
.end_amdhsa_kernel
```
